```python
import torch

def _softmax(x, axis=-1):
    return torch.softmax(x, dim=axis)

def _gelu(x):
    return torch.nn.functional.gelu(x, approximate='tanh')

def _silu(x):
    return torch.nn.functional.silu(x)

def _sigmoid(x):
    return torch.sigmoid(x)

def _layernorm(x, axis=-1, eps=1e-05):
    m = x.mean(dim=axis, keepdim=True)
    v = x.var(dim=axis, keepdim=True, unbiased=False)
    return (x - m) / torch.sqrt(v + eps)

def _scatter_add(tgt, idx, src, axis=0):
    return tgt.clone().index_add_(axis, idx, src)

def _segment_sum(src, seg, n):
    out = torch.zeros((n,) + src.shape[1:], dtype=src.dtype)
    return out.index_add_(0, seg, src)

def _pad(x, pw):
    flat = tuple((v for pair in reversed(pw) for v in pair))
    return torch.nn.functional.pad(x, flat)
kernel_name = 'standalone__autoregressive_conv_wavenet__speech'

def setup_inputs():

    _w = lambda a: (lambda t: t.to(torch.bfloat16) if t.is_floating_point() else t)(torch.as_tensor(a))
    B, T, D, K = (2, 1000, 144, 31)
    return {'x': _w((lambda *s: torch.randn(*s, dtype=torch.bfloat16) * 0.1)(B, T, D)), 'w': _w((lambda *s: torch.randn(*s, dtype=torch.bfloat16) * 0.1)(K, D, 2 * D)), 'w_o': _w((lambda *s: torch.randn(*s, dtype=torch.bfloat16) * 0.05)(D, D))}

def reference(x, w, w_o):
    B, T, D = x.shape
    K = w.shape[0]
    dil = 2
    pad = (K - 1) * dil
    xp = _pad(x, ((0, 0), (pad, 0), (0, 0)))
    h = torch.einsum('btc,cd->btd', xp[:, pad:pad + T, :], w[0])
    for i in range(1, K):
        off = pad - i * dil
        h = h + torch.einsum('btc,cd->btd', xp[:, off:off + T, :], w[i])
    f = h[..., :D].clone()
    g = h[..., D:].clone()
    z = torch.tanh(f) * _sigmoid(g)
    return z @ w_o
```

```asm
; @launch grid=(252,1,1) block=(512,1,1) lds=161280
.amdgcn_target "amdgcn-amd-amdhsa--gfx950"
.text
.globl standalone__autoregressive_conv_wavenet__speech_kernel
.p2align 12
.p2align 8
.type standalone__autoregressive_conv_wavenet__speech_kernel,@function
standalone__autoregressive_conv_wavenet__speech_kernel:
    v_lshrrev_b32 v1, 6, v0
    s_cmp_ge_u32 s2, 252
    v_readfirstlane_b32 s16, v1
    s_cbranch_scc1 L_end
    s_load_dwordx4 s[4:7], s[0:1], 0
    s_load_dwordx4 s[12:15], s[0:1], 32
    s_load_dwordx4 s[8:11], s[0:1], 16
    v_and_b32 v0, 63, v0
    s_and_b32 s21, s2, 1
    s_bfe_u32 s17, s2, 0x20001
    s_mul_i32 s18, s17, 31
    s_min_u32 s17, s17, 2
    s_add_u32 s17, s17, s18
    s_lshr_b32 s18, s2, 3
    s_add_u32 s23, s17, s18
    s_mul_i32 s17, s23, 147
    s_lshr_b32 s17, s17, 10
    s_mul_i32 s18, s17, 7
    s_sub_u32 s22, s23, s18
    s_mul_i32 s18, s21, 7
    s_add_u32 s18, s18, s22
    s_lshr_b32 s19, s17, 1
    s_and_b32 s20, s17, 1
    s_lshl_b32 s61, s16, 2
    s_add_u32 s61, s61, 38720
    v_mov_b32 v252, 128
    s_cmp_ge_u32 s16, 4
    s_cbranch_scc0 L_compute
L_loader:
    s_sub_u32 s45, s16, 4
    s_getpc_b64 s[52:53]
L_pc:
    s_lshr_b32 s54, s2, 3
    s_lshl_b32 s54, s54, 2
    s_add_u32 s54, s54, s45
    s_lshl_b32 s54, s54, 7
    s_min_u32 s54, s54, L_codeend-standalone__autoregressive_conv_wavenet__speech_kernel-4
    s_sub_u32 s54, s54, L_pc-standalone__autoregressive_conv_wavenet__speech_kernel
    s_ashr_i32 s55, s54, 31
    s_add_u32 s52, s52, s54
    s_addc_u32 s53, s53, s55
    v_mov_b32 v8, s52
    v_mov_b32 v9, s53
    s_mov_b64 exec, 1
    global_load_dword v253, v[8:9], off
    s_mov_b64 exec, -1
    s_cmp_lg_u32 s45, 3
    s_cselect_b32 s46, 1, 0
    v_mov_b32 v8, s46
    v_mov_b32 v9, s46
    v_mov_b32 v10, s46
    v_mov_b32 v11, s46
    s_lshl_b32 s46, s45, 8
    v_lshl_add_u32 v6, v0, 4, s46
    s_mov_b64 exec, 0xffff
    ds_write_b128 v6, v[8:11] offset:38720
    s_mov_b64 exec, -1
    v_lshrrev_b32 v4, 3, v0
    v_mul_u32_u24 v4, 1152, v4
    v_and_b32 v5, 7, v0
    v_bfe_u32 v6, v0, 4, 1
    v_lshlrev_b32 v6, 1, v6
    v_xor_b32 v5, v5, v6
    s_and_b32 s46, s45, 1
    s_lshl_b32 s46, s46, 2
    v_xor_b32 v5, s46, v5
    v_lshl_add_u32 v4, v5, 4, v4
    s_lshl_b32 s50, s19, 7
    s_lshl_b32 s47, s20, 2
    s_add_u32 s47, s47, s45
    s_mul_i32 s46, s47, 9216
    s_add_u32 s46, s46, s50
    s_lshl_b32 s48, s45, 10
    s_add_u32 s48, s48, 42496
    s_mov_b32 m0, s48
    s_mov_b32 s30, 2571264
    s_mov_b32 s31, 0x20000
    s_waitcnt lgkmcnt(0)
    s_mov_b32 s28, s6
    s_mov_b32 s29, s7
    buffer_load_dwordx4 v4, s[28:31], s46 offen  lds
    s_lshl_b32 s52, s18, 7
    s_add_u32 s52, s52, 4644864
    s_load_dword s63, s[14:15], s52
    s_barrier
    s_add_u32 m0, s61, 0
    s_mov_b64 exec, 1
    global_load_lds_dword v252, s[12:13]
    s_mov_b64 exec, -1
    s_add_u32 m0, s48, 4096
    s_add_u32 s50, s46, 82944
    buffer_load_dwordx4 v4, s[28:31], s50 offen  lds
    s_add_u32 m0, s61, 32
    s_mov_b64 exec, 1
    global_load_lds_dword v252, s[12:13]
    s_mov_b64 exec, -1
    s_add_u32 m0, s48, 8192
    s_add_u32 s50, s46, 165888
    buffer_load_dwordx4 v4, s[28:31], s50 offen  lds
    s_add_u32 m0, s61, 64
    s_mov_b64 exec, 1
    global_load_lds_dword v252, s[12:13]
    s_mov_b64 exec, -1
    s_add_u32 m0, s48, 12288
    s_add_u32 s50, s46, 248832
    buffer_load_dwordx4 v4, s[28:31], s50 offen  lds
    s_branch L_loader2
L_compute:
    v_mul_u32_u24 v16, 47, v0
    v_lshrrev_b32 v16, 9, v16
    v_mul_u32_u24 v17, 11, v16
    v_sub_u32 v17, v0, v17
    v_mul_u32_u24 v16, 288, v16
    v_lshl_add_u32 v16, v17, 4, v16
    s_mul_i32 s45, s22, 144
    s_add_u32 s45, s45, 140
    s_mul_i32 s46, s16, 5
    s_sub_u32 s45, s45, s46
    s_mul_i32 s45, s45, 288
    s_mul_i32 s46, s20, 160
    s_add_u32 s45, s45, s46
    s_sub_u32 s45, s45, 32
    v_add_u32 v16, s45, v16
    s_mul_i32 s46, s16, 880
    s_sub_u32 s46, 37840, s46
    s_mov_b32 m0, s46
    s_mov_b32 s26, 288000
    s_mov_b32 s27, 0x20000
    s_mul_i32 s23, s21, 288000
    v_and_b32 v3, 15, v0
    v_lshlrev_b32 v3, 2, v3
    v_add_u32 v3, 38720, v3
    v_lshlrev_b32 v2, 2, v1
    v_add_u32 v2, 39488, v2
    v_and_b32 v10, 15, v0
    v_lshrrev_b32 v11, 4, v0
    v_add_u32 v12, 4, v10
    v_and_b32 v13, 7, v12
    v_bfe_u32 v14, v12, 3, 1
    v_mad_u32_u24 v13, v13, 18, v14
    v_mul_u32_u24 v4, 176, v13
    v_mul_u32_u24 v14, 1408, v11
    v_sub_u32 v5, v4, v14
    v_lshl_add_u32 v4, v11, 5, v4
    s_lshl_b32 s44, s20, 5
    s_sub_u32 s44, 2672, s44
    v_add_u32 v4, s44, v4
    s_mul_i32 s44, s20, 5680
    s_sub_u32 s44, 12320, s44
    v_add_u32 v5, s44, v5
    v_lshrrev_b32 v14, 2, v10
    v_lshl_add_u32 v14, v11, 3, v14
    v_lshlrev_b32 v6, 7, v14
    v_bfe_u32 v14, v10, 1, 1
    s_lshl_b32 s44, s16, 1
    v_add_u32 v14, s44, v14
    v_bfe_u32 v15, v10, 3, 1
    v_lshlrev_b32 v15, 1, v15
    v_xor_b32 v14, v14, v15
    v_and_b32 v15, 1, v11
    v_lshlrev_b32 v15, 2, v15
    v_xor_b32 v14, v14, v15
    v_lshl_add_u32 v6, v14, 4, v6
    v_and_b32 v14, 1, v10
    v_lshl_add_u32 v6, v14, 3, v6
    v_add_u32 v6, 42496, v6
    v_add_u32 v7, 0x10000, v6
    s_mov_b32 exec_lo, 0xffdffbff
    s_mov_b32 exec_hi, 0x3ff7fe
    s_waitcnt lgkmcnt(0)
    s_add_u32 s24, s4, s23
    s_addc_u32 s25, s5, 0
    buffer_load_dwordx4 v16, s[24:27], 0 offen  lds
    s_sub_u32 m0, m0, 3520
    v_subrev_u32 v16, 5760, v16
    buffer_load_dwordx4 v16, s[24:27], 0 offen  lds
    s_barrier
    s_sub_u32 m0, m0, 3520
    v_subrev_u32 v16, 5760, v16
    buffer_load_dwordx4 v16, s[24:27], 0 offen  lds
    s_sub_u32 m0, m0, 3520
    v_subrev_u32 v16, 5760, v16
    buffer_load_dwordx4 v16, s[24:27], 0 offen  lds
    s_sub_u32 m0, m0, 3520
    v_subrev_u32 v16, 5760, v16
    buffer_load_dwordx4 v16, s[24:27], 0 offen  lds
    s_sub_u32 m0, m0, 3520
    v_subrev_u32 v16, 5760, v16
    buffer_load_dwordx4 v16, s[24:27], 0 offen  lds
    s_sub_u32 m0, m0, 3520
    v_subrev_u32 v16, 5760, v16
    buffer_load_dwordx4 v16, s[24:27], 0 offen  lds
    s_sub_u32 m0, m0, 3520
    v_subrev_u32 v16, 5760, v16
    buffer_load_dwordx4 v16, s[24:27], 0 offen  lds
    s_add_u32 m0, s61, 0
    s_mov_b64 exec, 1
    global_load_lds_dword v252, s[12:13]
    s_mov_b64 exec, -1
    s_lshl_b32 s52, s18, 7
    s_add_u32 s52, s52, 4644864
    s_load_dword s63, s[14:15], s52
    s_mov_b32 s40, s14
    s_mov_b32 s41, s15
    s_mov_b32 s42, 4646656
    s_mov_b32 s43, 0x20000
    s_mov_b32 s36, s10
    s_mov_b32 s37, s11
    s_mov_b32 s38, 576000
    s_mov_b32 s39, 0x20000
    s_lshl_b32 s96, s19, 2
    s_add_u32 s96, s96, s16
    s_cmp_ge_u32 s96, 18
    s_cselect_b32 s45, 1, 0
    s_mov_b32 s47, 0x05040100
    s_mov_b32 s46, 0x07060302
    s_cselect_b32 s47, s46, s47
    s_mul_i32 s97, s45, 18
    s_sub_u32 s96, s96, s97
    s_mul_i32 s48, s18, 1296
    s_lshl_b32 s96, s96, 2
    s_add_u32 s48, s48, s96
    s_lshl_b32 s97, s45, 1
    s_add_u32 s48, s48, s97
    s_add_u32 s48, s48, s20
    s_lshl_b32 s48, s48, 8
    v_and_b32 v64, 3, v10
    v_lshl_add_u32 v64, v64, 2, v11
    v_lshlrev_b32 v64, 4, v64
    v_lshrrev_b32 v65, 2, v10
    s_mov_b32 s96, 18432
    v_mad_u32_u24 v8, v65, s96, v64
    v_and_b32 v65, 1, v65
    v_mad_u32_u24 v9, v65, s96, v64
    v_lshrrev_b32 v65, 3, v10
    v_lshl_add_u32 v9, v65, 3, v9
    s_mul_i32 s3, s17, 7
    s_mul_i32 s96, s22, 3
    s_add_u32 s3, s3, s96
    s_mul_i32 s96, s3, 3641
    s_lshr_b32 s96, s96, 16
    s_mul_i32 s96, s96, 18
    s_sub_u32 s3, s3, s96
    v_and_b32 v64, 15, v0
    v_lshrrev_b32 v65, 4, v0
    v_and_b32 v66, 7, v64
    v_lshlrev_b32 v13, 4, v66
    v_lshl_add_u32 v13, v65, 7, v13
    v_add_u32 v13, 39744, v13
    v_lshrrev_b32 v66, 2, v64
    v_lshl_add_u32 v66, v65, 2, v66
    v_mul_u32_u24 v14, 288, v66
    v_and_b32 v66, 3, v64
    v_lshl_add_u32 v14, v66, 3, v14
    s_lshl_b32 s96, s16, 5
    s_add_u32 s97, s96, 67072
    v_add_u32 v14, s97, v14
    v_lshrrev_b32 v66, 1, v64
    v_and_b32 v66, 3, v66
    v_and_b32 v67, 1, v64
    s_and_b32 s97, s3, 3
    s_lshl_b32 s97, s97, 2
    s_add_u32 s97, s97, 4
    v_add_u32 v66, s97, v66
    s_cmp_ge_u32 s3, 16
    s_cselect_b32 s98, 8, 0
    s_cselect_b32 s99, 0, 2
    v_mad_u32_u24 v66, v67, s98, v66
    v_and_b32 v68, 7, v66
    v_bfe_u32 v69, v66, 3, 1
    v_mad_u32_u24 v68, v68, 18, v69
    v_mul_u32_u24 v67, s99, v67
    v_sub_u32 v68, v68, v67
    s_lshr_b32 s97, s3, 2
    s_lshl_b32 s97, s97, 2
    s_mul_i32 s98, s22, 144
    s_add_u32 s98, s98, 16
    s_sub_u32 s98, s98, s97
    v_add_u32 v68, s98, v68
    v_cmp_gt_u32 vcc, 1000, v68
    v_cmp_gt_u32 s[98:99], 8, v64
    s_mul_i32 s97, s21, 1000
    s_and_b64 vcc, vcc, s[98:99]
    v_add_u32 v68, s97, v68
    v_mul_u32_u24 v68, 288, v68
    v_lshl_add_u32 v68, v65, 3, v68
    v_add_u32 v68, s96, v68
    v_mov_b32 v69, 0x80000000
    v_cndmask_b32 v15, v69, v68, vcc
    v_mov_b32 v1, 1
    s_cmp_eq_u32 s20, 1
    s_cselect_b32 s50, 1, 0x10000
    s_cselect_b32 s51, 0x10000, 1
    v_and_b32 v11, 8, v0
    v_lshlrev_b32 v11, 13, v11
    v_mov_b32 v10, 0xfffefffe
    s_mov_b32 s4, 0x10001
    s_waitcnt lgkmcnt(0)
    s_add_u32 s63, s63, 1
    s_add_u32 s96, s63, 0
    s_and_b32 s97, s96, 1
    s_and_b32 s96, s96, 2
    s_lshl_b32 s96, s96, 15
    s_or_b32 s56, s96, s97
    s_add_u32 s96, s63, 1
    s_and_b32 s97, s96, 1
    s_and_b32 s96, s96, 2
    s_lshl_b32 s96, s96, 15
    s_or_b32 s57, s96, s97
    s_add_u32 s96, s63, 2
    s_and_b32 s97, s96, 1
    s_and_b32 s96, s96, 2
    s_lshl_b32 s96, s96, 15
    s_or_b32 s58, s96, s97
    s_add_u32 s96, s63, 3
    s_and_b32 s97, s96, 1
    s_and_b32 s96, s96, 2
    s_lshl_b32 s96, s96, 15
    s_or_b32 s59, s96, s97
    v_xor_b32 v254, s56, v11
    v_xor_b32 v255, s57, v11
    s_mov_b32 s60, 0
    s_cmp_lg_u32 s16, 0
    s_cbranch_scc1 L_nz
    v_and_b32 v113, 15, v0
    v_lshrrev_b32 v114, 4, v0
    v_and_b32 v115, 1, v113
    v_lshlrev_b32 v115, 4, v115
    v_mov_b32 v116, 0x3f80
    v_lshlrev_b32 v115, v115, v116
    v_lshrrev_b32 v116, 1, v113
    v_cmp_eq_u32 vcc, 0, v116
    s_nop 1
    v_cndmask_b32 v100, 0, v115, vcc
    v_cmp_eq_u32 vcc, 1, v116
    s_nop 1
    v_cndmask_b32 v101, 0, v115, vcc
    v_cmp_eq_u32 vcc, 2, v116
    s_nop 1
    v_cndmask_b32 v102, 0, v115, vcc
    v_cmp_eq_u32 vcc, 3, v116
    s_nop 1
    v_cndmask_b32 v103, 0, v115, vcc
    v_cmp_eq_u32 vcc, 4, v116
    s_nop 1
    v_cndmask_b32 v104, 0, v115, vcc
    v_cmp_eq_u32 vcc, 5, v116
    s_nop 1
    v_cndmask_b32 v105, 0, v115, vcc
    v_cmp_eq_u32 vcc, 6, v116
    s_nop 1
    v_cndmask_b32 v106, 0, v115, vcc
    v_cmp_eq_u32 vcc, 7, v116
    s_nop 1
    v_cndmask_b32 v107, 0, v115, vcc
    v_lshlrev_b32 v108, 4, v0
    v_lshrrev_b32 v115, 1, v114
    v_lshlrev_b32 v109, 3, v115
    v_and_b32 v115, 3, v113
    v_lshl_add_u32 v109, v115, 7, v109
    v_lshrrev_b32 v115, 2, v113
    v_lshl_add_u32 v109, v115, 5, v109
    v_and_b32 v115, 1, v114
    v_lshl_add_u32 v109, v115, 4, v109
    s_mul_i32 s4, s18, 18
    s_add_u32 s4, s4, s3
    s_mul_i32 s4, s4, 18432
    s_mov_b32 s5, 4
    s_lshl_b32 s10, s5, 11
    s_add_u32 s10, s10, s4
    s_add_u32 s11, s10, 9216
    s_lshl_b32 s96, s5, 9
    s_add_u32 s96, s96, 39744
    v_add_u32 v109, s96, v109
    s_mov_b32 s6, 0x4038aa3b
    s_mov_b32 s7, 0xbfb8aa3b
    v_mov_b32 v110, 0x42700000
    s_lshr_b32 s9, s3, 2
    s_add_u32 s9, s9, 1
    s_mov_b32 s4, 0x10001
    s_cmp_eq_u32 s5, 4
    s_cselect_b32 s8, 0, -1
L_nz:
    s_mov_b64 exec, 0
    s_cmp_eq_u32 s16, 1
    s_cbranch_scc1 L_pad0
    s_cmp_eq_u32 s16, 2
    s_cbranch_scc1 L_pad1
L_padret0:
L_padret1:
    s_mov_b64 exec, -1
    s_branch L_main
Lck_1_slow:
    ds_read_b32 v12, v3 offset:32
    s_waitcnt lgkmcnt(0)
    v_cmp_ne_u32 vcc, 0, v12
    s_and_b32 s62, vcc_lo, 0xf0
    s_cbranch_scc1 Lck_1_slow
    s_branch Lck_1_ok
Lck_2_slow:
    ds_read_b32 v12, v3 offset:64
    s_waitcnt lgkmcnt(0)
    v_cmp_ne_u32 vcc, 0, v12
    s_and_b32 s62, vcc_lo, 0xf0
    s_cbranch_scc1 Lck_2_slow
    s_branch Lck_2_ok
Lck_3_slow:
    ds_read_b32 v12, v3 offset:96
    s_waitcnt lgkmcnt(0)
    v_cmp_ne_u32 vcc, 0, v12
    s_and_b32 s62, vcc_lo, 0xf0
    s_cbranch_scc1 Lck_3_slow
    s_branch Lck_3_ok
Lck_4_slow:
    ds_read_b32 v12, v3 offset:128
    s_waitcnt lgkmcnt(0)
    v_cmp_ne_u32 vcc, 0, v12
    s_and_b32 s62, vcc_lo, 0xf0
    s_cbranch_scc1 Lck_4_slow
    s_branch Lck_4_ok
Lck_5_slow:
    ds_read_b32 v12, v3 offset:160
    s_waitcnt lgkmcnt(0)
    v_cmp_ne_u32 vcc, 0, v12
    s_and_b32 s62, vcc_lo, 0xf0
    s_cbranch_scc1 Lck_5_slow
    s_branch Lck_5_ok
Lck_6_slow:
    ds_read_b32 v12, v3 offset:192
    s_waitcnt lgkmcnt(0)
    v_cmp_ne_u32 vcc, 0, v12
    s_and_b32 s62, vcc_lo, 0xf0
    s_cbranch_scc1 Lck_6_slow
    s_branch Lck_6_ok
Lck_7_slow:
    ds_read_b32 v12, v3 offset:224
    s_waitcnt lgkmcnt(0)
    v_cmp_ne_u32 vcc, 0, v12
    s_and_b32 s62, vcc_lo, 0xf0
    s_cbranch_scc1 Lck_7_slow
    s_branch Lck_7_ok
Lck_8_slow:
    ds_read_b32 v12, v3 offset:256
    s_waitcnt lgkmcnt(0)
    v_cmp_ne_u32 vcc, 0, v12
    s_and_b32 s62, vcc_lo, 0xf0
    s_cbranch_scc1 Lck_8_slow
    s_branch Lck_8_ok
Lck_9_slow:
    ds_read_b32 v12, v3 offset:288
    s_waitcnt lgkmcnt(0)
    v_cmp_ne_u32 vcc, 0, v12
    s_and_b32 s62, vcc_lo, 0xf0
    s_cbranch_scc1 Lck_9_slow
    s_branch Lck_9_ok
Lck_10_slow:
    ds_read_b32 v12, v3 offset:320
    s_waitcnt lgkmcnt(0)
    v_cmp_ne_u32 vcc, 0, v12
    s_and_b32 s62, vcc_lo, 0xf0
    s_cbranch_scc1 Lck_10_slow
    s_branch Lck_10_ok
Lck_11_slow:
    ds_read_b32 v12, v3 offset:352
    s_waitcnt lgkmcnt(0)
    v_cmp_ne_u32 vcc, 0, v12
    s_and_b32 s62, vcc_lo, 0xf0
    s_cbranch_scc1 Lck_11_slow
    s_branch Lck_11_ok
Lck_12_slow:
    ds_read_b32 v12, v3 offset:384
    s_waitcnt lgkmcnt(0)
    v_cmp_ne_u32 vcc, 0, v12
    s_and_b32 s62, vcc_lo, 0xf0
    s_cbranch_scc1 Lck_12_slow
    s_branch Lck_12_ok
L_main:
Lsp1:
    ds_read_b32 v12, v3 offset:0
    s_waitcnt lgkmcnt(0)
    v_cmp_ne_u32 vcc, 0, v12
    s_and_b32 s62, vcc_lo, 0xff
    s_cbranch_scc1 Lsp1
    ds_read_b64_tr_b16 v[52:53], v6 offset:0
    ds_read_b64_tr_b16 v[54:55], v6 offset:512
    ds_read_b128 v[56:59], v4 offset:13376
    ds_read_b128 v[60:63], v4 offset:13392
    ds_read_b128 v[64:67], v4 offset:13024
    ds_read_b128 v[68:71], v4 offset:13040
    ds_read_b128 v[72:75], v4 offset:12672
    ds_read_b128 v[76:79], v4 offset:12688
    ds_read_b128 v[80:83], v4 offset:12320
    ds_read_b128 v[84:87], v4 offset:12336
    ds_read_b128 v[88:91], v4 offset:11968
    ds_read_b128 v[92:95], v4 offset:11984
    ds_read_b128 v[96:99], v4 offset:11616
    ds_read_b128 v[112:115], v4 offset:11632
    s_waitcnt lgkmcnt(10)
    v_perm_b32 v56, v57, v56, s47
    v_perm_b32 v57, v59, v58, s47
    v_perm_b32 v58, v61, v60, s47
    v_perm_b32 v59, v63, v62, s47
    ds_read_b128 v[116:119], v4 offset:11264
    ds_read_b128 v[120:123], v4 offset:11280
    s_waitcnt lgkmcnt(10)
    v_perm_b32 v64, v65, v64, s47
    v_perm_b32 v65, v67, v66, s47
    v_perm_b32 v66, v69, v68, s47
    v_perm_b32 v67, v71, v70, s47
    ds_read_b128 v[124:127], v4 offset:10912
    ds_read_b128 v[128:131], v4 offset:10928
    v_mfma_f32_16x16x32_bf16 v[48:51], v[52:55], v[56:59], 0
    ds_read_b32 v12, v3 offset:32
    s_waitcnt lgkmcnt(11)
    v_perm_b32 v72, v73, v72, s47
    v_perm_b32 v73, v75, v74, s47
    v_perm_b32 v74, v77, v76, s47
    v_perm_b32 v75, v79, v78, s47
    ds_read_b128 v[132:135], v4 offset:10560
    ds_read_b128 v[136:139], v4 offset:10576
    v_mfma_f32_16x16x32_bf16 v[44:47], v[52:55], v[64:67], 0
    s_waitcnt lgkmcnt(2)
    v_cmp_ne_u32 vcc, 0, v12
    v_perm_b32 v80, v81, v80, s47
    v_perm_b32 v81, v83, v82, s47
    v_perm_b32 v82, v85, v84, s47
    v_perm_b32 v83, v87, v86, s47
    v_mfma_f32_16x16x32_bf16 v[40:43], v[52:55], v[72:75], 0
    s_and_b32 s62, vcc_lo, 0xf0
    s_cbranch_scc1 Lck_1_slow
Lck_1_ok:
    v_perm_b32 v88, v89, v88, s47
    v_perm_b32 v89, v91, v90, s47
    v_perm_b32 v90, v93, v92, s47
    v_perm_b32 v91, v95, v94, s47
    v_mfma_f32_16x16x32_bf16 v[36:39], v[52:55], v[80:83], 0
    ds_read_b64_tr_b16 v[140:141], v6 offset:4096
    ds_read_b64_tr_b16 v[142:143], v6 offset:4608
    ds_read_b32 v12, v3 offset:64
    v_perm_b32 v96, v97, v96, s47
    v_perm_b32 v97, v99, v98, s47
    v_perm_b32 v98, v113, v112, s47
    v_perm_b32 v99, v115, v114, s47
    v_mfma_f32_16x16x32_bf16 v[32:35], v[52:55], v[88:91], 0
    v_perm_b32 v116, v117, v116, s47
    v_perm_b32 v117, v119, v118, s47
    v_perm_b32 v118, v121, v120, s47
    v_perm_b32 v119, v123, v122, s47
    v_mfma_f32_16x16x32_bf16 v[28:31], v[52:55], v[96:99], 0
    ds_read_b128 v[144:147], v4 offset:10208
    ds_read_b128 v[148:151], v4 offset:10224
    v_perm_b32 v124, v125, v124, s47
    v_perm_b32 v125, v127, v126, s47
    v_perm_b32 v126, v129, v128, s47
    v_perm_b32 v127, v131, v130, s47
    v_mfma_f32_16x16x32_bf16 v[24:27], v[52:55], v[116:119], 0
    s_waitcnt lgkmcnt(5)
    v_perm_b32 v132, v133, v132, s47
    v_perm_b32 v133, v135, v134, s47
    v_perm_b32 v134, v137, v136, s47
    v_perm_b32 v135, v139, v138, s47
    v_mfma_f32_16x16x32_bf16 v[20:23], v[52:55], v[124:127], 0
    s_waitcnt lgkmcnt(2)
    v_cmp_ne_u32 vcc, 0, v12
    v_mfma_f32_16x16x32_bf16 v[16:19], v[52:55], v[132:135], 0
    v_mfma_f32_16x16x32_bf16 v[48:51], v[140:143], v[64:67], v[48:51]
    s_and_b32 s62, vcc_lo, 0xf0
    s_cbranch_scc1 Lck_2_slow
Lck_2_ok:
    v_mfma_f32_16x16x32_bf16 v[44:47], v[140:143], v[72:75], v[44:47]
    s_waitcnt lgkmcnt(0)
    v_perm_b32 v144, v145, v144, s47
    v_mfma_f32_16x16x32_bf16 v[40:43], v[140:143], v[80:83], v[40:43]
    v_perm_b32 v145, v147, v146, s47
    v_perm_b32 v146, v149, v148, s47
    v_mfma_f32_16x16x32_bf16 v[36:39], v[140:143], v[88:91], v[36:39]
    ds_read_b64_tr_b16 v[152:153], v6 offset:8192
    ds_read_b64_tr_b16 v[154:155], v6 offset:8704
    ds_read_b32 v12, v3 offset:96
    v_mfma_f32_16x16x32_bf16 v[32:35], v[140:143], v[96:99], v[32:35]
    v_perm_b32 v147, v151, v150, s47
    v_mfma_f32_16x16x32_bf16 v[28:31], v[140:143], v[116:119], v[28:31]
    ds_read_b128 v[156:159], v4 offset:9856
    ds_read_b128 v[160:163], v4 offset:9872
    v_mfma_f32_16x16x32_bf16 v[24:27], v[140:143], v[124:127], v[24:27]
    v_mfma_f32_16x16x32_bf16 v[20:23], v[140:143], v[132:135], v[20:23]
    s_waitcnt lgkmcnt(2)
    v_cmp_ne_u32 vcc, 0, v12
    v_mfma_f32_16x16x32_bf16 v[16:19], v[140:143], v[144:147], v[16:19]
    v_mfma_f32_16x16x32_bf16 v[48:51], v[152:155], v[72:75], v[48:51]
    s_and_b32 s62, vcc_lo, 0xf0
    s_cbranch_scc1 Lck_3_slow
Lck_3_ok:
    v_mfma_f32_16x16x32_bf16 v[44:47], v[152:155], v[80:83], v[44:47]
    s_waitcnt lgkmcnt(0)
    v_perm_b32 v156, v157, v156, s47
    v_mfma_f32_16x16x32_bf16 v[40:43], v[152:155], v[88:91], v[40:43]
    v_perm_b32 v157, v159, v158, s47
    v_perm_b32 v158, v161, v160, s47
    v_mfma_f32_16x16x32_bf16 v[36:39], v[152:155], v[96:99], v[36:39]
    ds_read_b64_tr_b16 v[164:165], v6 offset:12288
    ds_read_b64_tr_b16 v[166:167], v6 offset:12800
    v_mfma_f32_16x16x32_bf16 v[32:35], v[152:155], v[116:119], v[32:35]
    ds_read_b64_tr_b16 v[168:169], v6 offset:16384
    ds_read_b64_tr_b16 v[170:171], v6 offset:16896
    v_mfma_f32_16x16x32_bf16 v[28:31], v[152:155], v[124:127], v[28:31]
    v_perm_b32 v159, v163, v162, s47
    v_mfma_f32_16x16x32_bf16 v[24:27], v[152:155], v[132:135], v[24:27]
    v_mfma_f32_16x16x32_bf16 v[20:23], v[152:155], v[144:147], v[20:23]
    v_mfma_f32_16x16x32_bf16 v[16:19], v[152:155], v[156:159], v[16:19]
    s_waitcnt lgkmcnt(2)
    v_mfma_f32_16x16x32_bf16 v[48:51], v[164:167], v[80:83], v[48:51]
    s_waitcnt lgkmcnt(0)
    v_mfma_f32_16x16x32_bf16 v[48:51], v[168:171], v[88:91], v[48:51]
    ds_read_b32 v12, v3 offset:128
    v_mfma_f32_16x16x32_bf16 v[44:47], v[164:167], v[88:91], v[44:47]
    ds_read_b128 v[172:175], v4 offset:9504
    ds_read_b128 v[176:179], v4 offset:9520
    v_mfma_f32_16x16x32_bf16 v[44:47], v[168:171], v[96:99], v[44:47]
    v_mfma_f32_16x16x32_bf16 v[40:43], v[164:167], v[96:99], v[40:43]
    v_mfma_f32_16x16x32_bf16 v[40:43], v[168:171], v[116:119], v[40:43]
    ds_read_b128 v[180:183], v4 offset:9152
    ds_read_b128 v[184:187], v4 offset:9168
    v_mfma_f32_16x16x32_bf16 v[36:39], v[164:167], v[116:119], v[36:39]
    s_waitcnt lgkmcnt(4)
    v_cmp_ne_u32 vcc, 0, v12
    v_mfma_f32_16x16x32_bf16 v[36:39], v[168:171], v[124:127], v[36:39]
    s_waitcnt lgkmcnt(2)
    v_perm_b32 v172, v173, v172, s47
    v_mfma_f32_16x16x32_bf16 v[32:35], v[164:167], v[124:127], v[32:35]
    v_perm_b32 v173, v175, v174, s47
    v_perm_b32 v174, v177, v176, s47
    v_mfma_f32_16x16x32_bf16 v[32:35], v[168:171], v[132:135], v[32:35]
    s_and_b32 s62, vcc_lo, 0xf0
    s_cbranch_scc1 Lck_4_slow
Lck_4_ok:
    v_perm_b32 v175, v179, v178, s47
    v_mfma_f32_16x16x32_bf16 v[28:31], v[164:167], v[132:135], v[28:31]
    s_waitcnt lgkmcnt(0)
    v_perm_b32 v180, v181, v180, s47
    v_mfma_f32_16x16x32_bf16 v[28:31], v[168:171], v[144:147], v[28:31]
    v_perm_b32 v181, v183, v182, s47
    v_perm_b32 v182, v185, v184, s47
    v_mfma_f32_16x16x32_bf16 v[24:27], v[164:167], v[144:147], v[24:27]
    ds_read_b64_tr_b16 v[188:189], v6 offset:20480
    ds_read_b64_tr_b16 v[190:191], v6 offset:20992
    v_mfma_f32_16x16x32_bf16 v[24:27], v[168:171], v[156:159], v[24:27]
    ds_read_b64_tr_b16 v[192:193], v6 offset:24576
    ds_read_b64_tr_b16 v[194:195], v6 offset:25088
    v_mfma_f32_16x16x32_bf16 v[20:23], v[164:167], v[156:159], v[20:23]
    v_perm_b32 v183, v187, v186, s47
    v_mfma_f32_16x16x32_bf16 v[20:23], v[168:171], v[172:175], v[20:23]
    v_mfma_f32_16x16x32_bf16 v[16:19], v[164:167], v[172:175], v[16:19]
    v_mfma_f32_16x16x32_bf16 v[16:19], v[168:171], v[180:183], v[16:19]
    s_waitcnt lgkmcnt(2)
    v_mfma_f32_16x16x32_bf16 v[48:51], v[188:191], v[96:99], v[48:51]
    s_waitcnt lgkmcnt(0)
    v_mfma_f32_16x16x32_bf16 v[48:51], v[192:195], v[116:119], v[48:51]
    ds_read_b32 v12, v3 offset:160
    v_mfma_f32_16x16x32_bf16 v[44:47], v[188:191], v[116:119], v[44:47]
    ds_read_b128 v[196:199], v4 offset:8800
    ds_read_b128 v[200:203], v4 offset:8816
    v_mfma_f32_16x16x32_bf16 v[44:47], v[192:195], v[124:127], v[44:47]
    v_mfma_f32_16x16x32_bf16 v[40:43], v[188:191], v[124:127], v[40:43]
    v_mfma_f32_16x16x32_bf16 v[40:43], v[192:195], v[132:135], v[40:43]
    ds_read_b128 v[204:207], v4 offset:8448
    ds_read_b128 v[208:211], v4 offset:8464
    v_mfma_f32_16x16x32_bf16 v[36:39], v[188:191], v[132:135], v[36:39]
    s_waitcnt lgkmcnt(4)
    v_cmp_ne_u32 vcc, 0, v12
    v_mfma_f32_16x16x32_bf16 v[36:39], v[192:195], v[144:147], v[36:39]
    s_waitcnt lgkmcnt(2)
    v_perm_b32 v196, v197, v196, s47
    v_mfma_f32_16x16x32_bf16 v[32:35], v[188:191], v[144:147], v[32:35]
    v_perm_b32 v197, v199, v198, s47
    v_perm_b32 v198, v201, v200, s47
    v_mfma_f32_16x16x32_bf16 v[32:35], v[192:195], v[156:159], v[32:35]
    s_and_b32 s62, vcc_lo, 0xf0
    s_cbranch_scc1 Lck_5_slow
Lck_5_ok:
    v_perm_b32 v199, v203, v202, s47
    v_mfma_f32_16x16x32_bf16 v[28:31], v[188:191], v[156:159], v[28:31]
    s_waitcnt lgkmcnt(0)
    v_perm_b32 v204, v205, v204, s47
    v_mfma_f32_16x16x32_bf16 v[28:31], v[192:195], v[172:175], v[28:31]
    v_perm_b32 v205, v207, v206, s47
    v_perm_b32 v206, v209, v208, s47
    v_mfma_f32_16x16x32_bf16 v[24:27], v[188:191], v[172:175], v[24:27]
    ds_read_b64_tr_b16 v[212:213], v6 offset:28672
    ds_read_b64_tr_b16 v[214:215], v6 offset:29184
    v_mfma_f32_16x16x32_bf16 v[24:27], v[192:195], v[180:183], v[24:27]
    ds_read_b64_tr_b16 v[216:217], v6 offset:32768
    ds_read_b64_tr_b16 v[218:219], v6 offset:33280
    v_mfma_f32_16x16x32_bf16 v[20:23], v[188:191], v[180:183], v[20:23]
    v_perm_b32 v207, v211, v210, s47
    v_mfma_f32_16x16x32_bf16 v[20:23], v[192:195], v[196:199], v[20:23]
    v_mfma_f32_16x16x32_bf16 v[16:19], v[188:191], v[196:199], v[16:19]
    v_mfma_f32_16x16x32_bf16 v[16:19], v[192:195], v[204:207], v[16:19]
    s_waitcnt lgkmcnt(2)
    v_mfma_f32_16x16x32_bf16 v[48:51], v[212:215], v[124:127], v[48:51]
    s_waitcnt lgkmcnt(0)
    v_mfma_f32_16x16x32_bf16 v[48:51], v[216:219], v[132:135], v[48:51]
    ds_read_b32 v12, v3 offset:192
    s_barrier
    v_mfma_f32_16x16x32_bf16 v[44:47], v[212:215], v[132:135], v[44:47]
    ds_read_b128 v[220:223], v4 offset:8096
    ds_read_b128 v[224:227], v4 offset:8112
L_pad0:
    s_cbranch_execz L_padret0
    v_mfma_f32_16x16x32_bf16 v[44:47], v[216:219], v[144:147], v[44:47]
    v_mfma_f32_16x16x32_bf16 v[40:43], v[212:215], v[144:147], v[40:43]
    v_mfma_f32_16x16x32_bf16 v[40:43], v[216:219], v[156:159], v[40:43]
    ds_read_b128 v[228:231], v4 offset:7744
    ds_read_b128 v[232:235], v4 offset:7760
    v_mfma_f32_16x16x32_bf16 v[36:39], v[212:215], v[156:159], v[36:39]
    s_waitcnt lgkmcnt(4)
    v_cmp_ne_u32 vcc, 0, v12
    v_mfma_f32_16x16x32_bf16 v[36:39], v[216:219], v[172:175], v[36:39]
    s_waitcnt lgkmcnt(2)
    v_perm_b32 v220, v221, v220, s47
    v_mfma_f32_16x16x32_bf16 v[32:35], v[212:215], v[172:175], v[32:35]
    v_perm_b32 v221, v223, v222, s47
    v_perm_b32 v222, v225, v224, s47
    v_mfma_f32_16x16x32_bf16 v[32:35], v[216:219], v[180:183], v[32:35]
    s_and_b32 s62, vcc_lo, 0xf0
    s_cbranch_scc1 Lck_6_slow
Lck_6_ok:
    v_perm_b32 v223, v227, v226, s47
    v_mfma_f32_16x16x32_bf16 v[28:31], v[212:215], v[180:183], v[28:31]
    s_waitcnt lgkmcnt(0)
    v_perm_b32 v228, v229, v228, s47
    v_mfma_f32_16x16x32_bf16 v[28:31], v[216:219], v[196:199], v[28:31]
    v_perm_b32 v229, v231, v230, s47
    v_perm_b32 v230, v233, v232, s47
    v_mfma_f32_16x16x32_bf16 v[24:27], v[212:215], v[196:199], v[24:27]
    ds_read_b64_tr_b16 v[236:237], v6 offset:36864
    ds_read_b64_tr_b16 v[238:239], v6 offset:37376
    v_mfma_f32_16x16x32_bf16 v[24:27], v[216:219], v[204:207], v[24:27]
    ds_read_b64_tr_b16 v[240:241], v6 offset:40960
    ds_read_b64_tr_b16 v[242:243], v6 offset:41472
    v_mfma_f32_16x16x32_bf16 v[20:23], v[212:215], v[204:207], v[20:23]
    v_perm_b32 v231, v235, v234, s47
    v_mfma_f32_16x16x32_bf16 v[20:23], v[216:219], v[220:223], v[20:23]
    v_mfma_f32_16x16x32_bf16 v[16:19], v[212:215], v[220:223], v[16:19]
    v_mfma_f32_16x16x32_bf16 v[16:19], v[216:219], v[228:231], v[16:19]
    s_waitcnt lgkmcnt(2)
    v_mfma_f32_16x16x32_bf16 v[48:51], v[236:239], v[144:147], v[48:51]
    s_waitcnt lgkmcnt(0)
    v_mfma_f32_16x16x32_bf16 v[48:51], v[240:243], v[156:159], v[48:51]
    ds_read_b32 v12, v3 offset:224
    v_mfma_f32_16x16x32_bf16 v[44:47], v[236:239], v[156:159], v[44:47]
    ds_read_b128 v[244:247], v4 offset:7392
    ds_read_b128 v[248:251], v4 offset:7408
    v_mfma_f32_16x16x32_bf16 v[44:47], v[240:243], v[172:175], v[44:47]
    v_mfma_f32_16x16x32_bf16 v[40:43], v[236:239], v[172:175], v[40:43]
    v_mfma_f32_16x16x32_bf16 v[40:43], v[240:243], v[180:183], v[40:43]
    ds_read_b128 v[60:63], v4 offset:7040
    ds_read_b128 v[68:71], v4 offset:7056
    v_mfma_f32_16x16x32_bf16 v[36:39], v[236:239], v[180:183], v[36:39]
    s_waitcnt lgkmcnt(4)
    v_cmp_ne_u32 vcc, 0, v12
    v_mfma_f32_16x16x32_bf16 v[36:39], v[240:243], v[196:199], v[36:39]
    s_waitcnt lgkmcnt(2)
    v_perm_b32 v244, v245, v244, s47
    v_mfma_f32_16x16x32_bf16 v[32:35], v[236:239], v[196:199], v[32:35]
    v_perm_b32 v245, v247, v246, s47
    v_perm_b32 v246, v249, v248, s47
    v_mfma_f32_16x16x32_bf16 v[32:35], v[240:243], v[204:207], v[32:35]
    s_and_b32 s62, vcc_lo, 0xf0
    s_cbranch_scc1 Lck_7_slow
Lck_7_ok:
    v_perm_b32 v247, v251, v250, s47
    v_mfma_f32_16x16x32_bf16 v[28:31], v[236:239], v[204:207], v[28:31]
    s_waitcnt lgkmcnt(0)
    v_perm_b32 v60, v61, v60, s47
    v_mfma_f32_16x16x32_bf16 v[28:31], v[240:243], v[220:223], v[28:31]
    v_perm_b32 v61, v63, v62, s47
    v_perm_b32 v62, v69, v68, s47
    v_mfma_f32_16x16x32_bf16 v[24:27], v[236:239], v[220:223], v[24:27]
    ds_read_b64_tr_b16 v[56:57], v6 offset:45056
    ds_read_b64_tr_b16 v[58:59], v6 offset:45568
    v_mfma_f32_16x16x32_bf16 v[24:27], v[240:243], v[228:231], v[24:27]
    ds_read_b64_tr_b16 v[76:77], v6 offset:49152
    ds_read_b64_tr_b16 v[78:79], v6 offset:49664
    v_mfma_f32_16x16x32_bf16 v[20:23], v[236:239], v[228:231], v[20:23]
    v_perm_b32 v63, v71, v70, s47
    v_mfma_f32_16x16x32_bf16 v[20:23], v[240:243], v[244:247], v[20:23]
    v_mfma_f32_16x16x32_bf16 v[16:19], v[236:239], v[244:247], v[16:19]
    ds_read_b128 v[84:87], v4 offset:6688
    ds_read_b128 v[92:95], v4 offset:6704
    v_mfma_f32_16x16x32_bf16 v[16:19], v[240:243], v[60:63], v[16:19]
    s_waitcnt lgkmcnt(4)
    v_mfma_f32_16x16x32_bf16 v[48:51], v[56:59], v[172:175], v[48:51]
    s_waitcnt lgkmcnt(2)
    v_mfma_f32_16x16x32_bf16 v[48:51], v[76:79], v[180:183], v[48:51]
    ds_read_b128 v[112:115], v4 offset:6336
    ds_read_b128 v[120:123], v4 offset:6352
    v_mfma_f32_16x16x32_bf16 v[44:47], v[56:59], v[180:183], v[44:47]
    v_mfma_f32_16x16x32_bf16 v[44:47], v[76:79], v[196:199], v[44:47]
    s_waitcnt lgkmcnt(2)
    v_perm_b32 v84, v85, v84, s47
    v_mfma_f32_16x16x32_bf16 v[40:43], v[56:59], v[196:199], v[40:43]
    v_perm_b32 v85, v87, v86, s47
    v_perm_b32 v86, v93, v92, s47
    v_mfma_f32_16x16x32_bf16 v[40:43], v[76:79], v[204:207], v[40:43]
    ds_read_b128 v[128:131], v4 offset:5984
    ds_read_b128 v[136:139], v4 offset:6000
    v_mfma_f32_16x16x32_bf16 v[36:39], v[56:59], v[204:207], v[36:39]
    s_waitcnt lgkmcnt(2)
    v_perm_b32 v112, v113, v112, s47
    ds_read_b32 v12, v3 offset:256
    v_mfma_f32_16x16x32_bf16 v[36:39], v[76:79], v[220:223], v[36:39]
    v_perm_b32 v113, v115, v114, s47
    v_perm_b32 v114, v121, v120, s47
    v_mfma_f32_16x16x32_bf16 v[32:35], v[56:59], v[220:223], v[32:35]
    v_perm_b32 v115, v123, v122, s47
    v_perm_b32 v87, v95, v94, s47
    v_mfma_f32_16x16x32_bf16 v[32:35], v[76:79], v[228:231], v[32:35]
    ds_read_b128 v[52:55], v4 offset:5632
    ds_read_b128 v[64:67], v4 offset:5648
    v_mfma_f32_16x16x32_bf16 v[28:31], v[56:59], v[228:231], v[28:31]
    s_waitcnt lgkmcnt(2)
    v_cmp_ne_u32 vcc, 0, v12
    v_perm_b32 v128, v129, v128, s47
    v_mfma_f32_16x16x32_bf16 v[28:31], v[76:79], v[244:247], v[28:31]
    s_and_b32 s62, vcc_lo, 0xf0
    s_cbranch_scc1 Lck_8_slow
Lck_8_ok:
    v_perm_b32 v129, v131, v130, s47
    v_perm_b32 v130, v137, v136, s47
    v_mfma_f32_16x16x32_bf16 v[24:27], v[56:59], v[244:247], v[24:27]
    ds_read_b64_tr_b16 v[148:149], v6 offset:53248
    ds_read_b64_tr_b16 v[150:151], v6 offset:53760
    v_mfma_f32_16x16x32_bf16 v[24:27], v[76:79], v[60:63], v[24:27]
    ds_read_b64_tr_b16 v[140:141], v6 offset:57344
    ds_read_b64_tr_b16 v[142:143], v6 offset:57856
    v_mfma_f32_16x16x32_bf16 v[20:23], v[56:59], v[60:63], v[20:23]
    s_waitcnt lgkmcnt(4)
    v_perm_b32 v52, v53, v52, s47
    v_mfma_f32_16x16x32_bf16 v[20:23], v[76:79], v[84:87], v[20:23]
    v_perm_b32 v53, v55, v54, s47
    v_perm_b32 v54, v65, v64, s47
    v_mfma_f32_16x16x32_bf16 v[16:19], v[56:59], v[84:87], v[16:19]
    ds_read_b128 v[72:75], v4 offset:5280
    ds_read_b128 v[160:163], v4 offset:5296
    v_mfma_f32_16x16x32_bf16 v[16:19], v[76:79], v[112:115], v[16:19]
    s_waitcnt lgkmcnt(4)
    v_mfma_f32_16x16x32_bf16 v[48:51], v[148:151], v[196:199], v[48:51]
    s_waitcnt lgkmcnt(2)
    v_mfma_f32_16x16x32_bf16 v[48:51], v[140:143], v[204:207], v[48:51]
    v_perm_b32 v55, v67, v66, s47
    v_perm_b32 v131, v139, v138, s47
    v_mfma_f32_16x16x32_bf16 v[44:47], v[148:151], v[204:207], v[44:47]
    ds_read_b128 v[152:155], v4 offset:4928
    ds_read_b128 v[80:83], v4 offset:4944
    v_mfma_f32_16x16x32_bf16 v[44:47], v[140:143], v[220:223], v[44:47]
    s_waitcnt lgkmcnt(2)
    v_perm_b32 v72, v73, v72, s47
    v_mfma_f32_16x16x32_bf16 v[40:43], v[148:151], v[220:223], v[40:43]
    ds_read_b128 v[88:91], v4 offset:4576
    ds_read_b128 v[176:179], v4 offset:4592
    v_mfma_f32_16x16x32_bf16 v[40:43], v[140:143], v[228:231], v[40:43]
    v_perm_b32 v73, v75, v74, s47
    v_perm_b32 v74, v161, v160, s47
    v_mfma_f32_16x16x32_bf16 v[36:39], v[148:151], v[228:231], v[36:39]
    ds_read_b128 v[184:187], v4 offset:4224
    ds_read_b128 v[164:167], v4 offset:4240
    ds_read_b32 v12, v3 offset:288
    v_mfma_f32_16x16x32_bf16 v[36:39], v[140:143], v[244:247], v[36:39]
    s_waitcnt lgkmcnt(5)
    v_perm_b32 v152, v153, v152, s47
    v_mfma_f32_16x16x32_bf16 v[32:35], v[148:151], v[244:247], v[32:35]
    v_perm_b32 v153, v155, v154, s47
    v_perm_b32 v154, v81, v80, s47
    v_mfma_f32_16x16x32_bf16 v[32:35], v[140:143], v[60:63], v[32:35]
    s_waitcnt lgkmcnt(3)
    v_perm_b32 v88, v89, v88, s47
    v_mfma_f32_16x16x32_bf16 v[28:31], v[148:151], v[60:63], v[28:31]
    s_waitcnt lgkmcnt(0)
    v_cmp_ne_u32 vcc, 0, v12
    v_perm_b32 v89, v91, v90, s47
    v_perm_b32 v90, v177, v176, s47
    v_mfma_f32_16x16x32_bf16 v[28:31], v[140:143], v[84:87], v[28:31]
    s_and_b32 s62, vcc_lo, 0xf0
    s_cbranch_scc1 Lck_9_slow
Lck_9_ok:
    v_perm_b32 v184, v185, v184, s47
    v_mfma_f32_16x16x32_bf16 v[24:27], v[148:151], v[84:87], v[24:27]
    ds_read_b64_tr_b16 v[168:169], v6 offset:61440
    ds_read_b64_tr_b16 v[170:171], v6 offset:61952
    v_mfma_f32_16x16x32_bf16 v[24:27], v[140:143], v[112:115], v[24:27]
    ds_read_b64_tr_b16 v[96:97], v7 offset:0
    ds_read_b64_tr_b16 v[98:99], v7 offset:512
    v_mfma_f32_16x16x32_bf16 v[20:23], v[148:151], v[112:115], v[20:23]
    v_perm_b32 v185, v187, v186, s47
    v_perm_b32 v186, v165, v164, s47
    v_mfma_f32_16x16x32_bf16 v[20:23], v[140:143], v[128:131], v[20:23]
    ds_read_b128 v[116:119], v5 offset:3872
    ds_read_b128 v[200:203], v5 offset:3888
    v_mfma_f32_16x16x32_bf16 v[16:19], v[148:151], v[128:131], v[16:19]
    ds_read_b128 v[208:211], v5 offset:3520
    ds_read_b128 v[188:191], v5 offset:3536
    v_mfma_f32_16x16x32_bf16 v[16:19], v[140:143], v[52:55], v[16:19]
    v_perm_b32 v75, v163, v162, s47
    s_waitcnt lgkmcnt(6)
    v_mfma_f32_16x16x32_bf16 v[48:51], v[168:171], v[220:223], v[48:51]
    v_perm_b32 v155, v83, v82, s47
    s_waitcnt lgkmcnt(4)
    v_mfma_f32_16x16x32_bf16 v[48:51], v[96:99], v[228:231], v[48:51]
    v_perm_b32 v187, v167, v166, s47
    v_perm_b32 v91, v179, v178, s47
    v_mfma_f32_16x16x32_bf16 v[44:47], v[168:171], v[228:231], v[44:47]
    s_waitcnt lgkmcnt(2)
    v_perm_b32 v116, v117, v116, s47
    v_mfma_f32_16x16x32_bf16 v[44:47], v[96:99], v[244:247], v[44:47]
    v_perm_b32 v117, v119, v118, s47
    v_perm_b32 v118, v201, v200, s47
    v_mfma_f32_16x16x32_bf16 v[40:43], v[168:171], v[244:247], v[40:43]
    ds_read_b128 v[192:195], v5 offset:3168
    ds_read_b128 v[124:127], v5 offset:3184
    v_mfma_f32_16x16x32_bf16 v[40:43], v[96:99], v[60:63], v[40:43]
    s_waitcnt lgkmcnt(2)
    v_perm_b32 v208, v209, v208, s47
    v_mfma_f32_16x16x32_bf16 v[36:39], v[168:171], v[60:63], v[36:39]
    ds_read_b128 v[132:135], v5 offset:2816
    ds_read_b128 v[224:227], v5 offset:2832
    ds_read_b32 v12, v3 offset:320
    v_mfma_f32_16x16x32_bf16 v[36:39], v[96:99], v[84:87], v[36:39]
    v_perm_b32 v209, v211, v210, s47
    v_perm_b32 v210, v189, v188, s47
    v_mfma_f32_16x16x32_bf16 v[32:35], v[168:171], v[84:87], v[32:35]
    v_perm_b32 v211, v191, v190, s47
    v_perm_b32 v119, v203, v202, s47
    v_mfma_f32_16x16x32_bf16 v[32:35], v[96:99], v[112:115], v[32:35]
    s_waitcnt lgkmcnt(3)
    v_perm_b32 v192, v193, v192, s47
    v_mfma_f32_16x16x32_bf16 v[28:31], v[168:171], v[112:115], v[28:31]
    s_waitcnt lgkmcnt(0)
    v_cmp_ne_u32 vcc, 0, v12
    v_perm_b32 v193, v195, v194, s47
    v_perm_b32 v194, v125, v124, s47
    v_mfma_f32_16x16x32_bf16 v[28:31], v[96:99], v[128:131], v[28:31]
    s_and_b32 s62, vcc_lo, 0xf0
    s_cbranch_scc1 Lck_10_slow
Lck_10_ok:
    v_perm_b32 v132, v133, v132, s47
    v_mfma_f32_16x16x32_bf16 v[24:27], v[168:171], v[128:131], v[24:27]
    ds_read_b64_tr_b16 v[232:233], v7 offset:4096
    ds_read_b64_tr_b16 v[234:235], v7 offset:4608
    v_mfma_f32_16x16x32_bf16 v[24:27], v[96:99], v[52:55], v[24:27]
    ds_read_b64_tr_b16 v[212:213], v7 offset:8192
    ds_read_b64_tr_b16 v[214:215], v7 offset:8704
    v_mfma_f32_16x16x32_bf16 v[20:23], v[168:171], v[52:55], v[20:23]
    ds_read_b128 v[216:219], v4 offset:3872
    ds_read_b128 v[144:147], v4 offset:3888
    v_mfma_f32_16x16x32_bf16 v[20:23], v[96:99], v[72:75], v[20:23]
    v_perm_b32 v133, v135, v134, s47
    v_perm_b32 v134, v225, v224, s47
    v_mfma_f32_16x16x32_bf16 v[16:19], v[168:171], v[72:75], v[16:19]
    ds_read_b128 v[156:159], v4 offset:3520
    ds_read_b128 v[248:251], v4 offset:3536
    v_mfma_f32_16x16x32_bf16 v[16:19], v[96:99], v[152:155], v[16:19]
    v_perm_b32 v195, v127, v126, s47
    s_waitcnt lgkmcnt(6)
    v_mfma_f32_16x16x32_bf16 v[48:51], v[232:235], v[244:247], v[48:51]
    v_perm_b32 v135, v227, v226, s47
    s_waitcnt lgkmcnt(4)
    v_mfma_f32_16x16x32_bf16 v[48:51], v[212:215], v[60:63], v[48:51]
    s_waitcnt lgkmcnt(2)
    v_perm_b32 v216, v217, v216, s47
    s_barrier
    v_mfma_f32_16x16x32_bf16 v[44:47], v[232:235], v[60:63], v[44:47]
    v_perm_b32 v217, v219, v218, s47
    v_perm_b32 v218, v145, v144, s47
    v_mfma_f32_16x16x32_bf16 v[44:47], v[212:215], v[84:87], v[44:47]
    ds_read_b128 v[68:71], v4 offset:3168
    ds_read_b128 v[236:239], v4 offset:3184
    v_mfma_f32_16x16x32_bf16 v[40:43], v[232:235], v[84:87], v[40:43]
    s_waitcnt lgkmcnt(2)
    v_perm_b32 v156, v157, v156, s47
    v_mfma_f32_16x16x32_bf16 v[40:43], v[212:215], v[112:115], v[40:43]
    ds_read_b128 v[240:243], v4 offset:2816
    ds_read_b128 v[172:175], v4 offset:2832
    v_mfma_f32_16x16x32_bf16 v[36:39], v[232:235], v[112:115], v[36:39]
    v_perm_b32 v157, v159, v158, s47
    v_perm_b32 v158, v249, v248, s47
    ds_read_b32 v12, v3 offset:352
    v_mfma_f32_16x16x32_bf16 v[36:39], v[212:215], v[128:131], v[36:39]
    v_perm_b32 v159, v251, v250, s47
    v_perm_b32 v219, v147, v146, s47
    v_mfma_f32_16x16x32_bf16 v[32:35], v[232:235], v[128:131], v[32:35]
    s_waitcnt lgkmcnt(3)
    v_perm_b32 v68, v69, v68, s47
    v_mfma_f32_16x16x32_bf16 v[32:35], v[212:215], v[52:55], v[32:35]
    v_perm_b32 v69, v71, v70, s47
    v_perm_b32 v70, v237, v236, s47
    v_mfma_f32_16x16x32_bf16 v[28:31], v[232:235], v[52:55], v[28:31]
    s_waitcnt lgkmcnt(0)
    v_cmp_ne_u32 vcc, 0, v12
    v_perm_b32 v240, v241, v240, s47
    v_mfma_f32_16x16x32_bf16 v[28:31], v[212:215], v[72:75], v[28:31]
    s_and_b32 s62, vcc_lo, 0xf0
    s_cbranch_scc1 Lck_11_slow
Lck_11_ok:
    ds_read_b128 v[180:183], v5 offset:2464
    ds_read_b128 v[120:123], v5 offset:2480
    v_mfma_f32_16x16x32_bf16 v[24:27], v[232:235], v[72:75], v[24:27]
    ds_read_b64_tr_b16 v[92:93], v7 offset:12288
    ds_read_b64_tr_b16 v[94:95], v7 offset:12800
    v_mfma_f32_16x16x32_bf16 v[24:27], v[212:215], v[152:155], v[24:27]
    ds_read_b64_tr_b16 v[56:57], v7 offset:16384
    ds_read_b64_tr_b16 v[58:59], v7 offset:16896
    v_mfma_f32_16x16x32_bf16 v[20:23], v[232:235], v[152:155], v[20:23]
    ds_read_b64_tr_b16 v[76:77], v7 offset:20480
    ds_read_b64_tr_b16 v[78:79], v7 offset:20992
    ds_read_b32 v12, v3 offset:384
    v_mfma_f32_16x16x32_bf16 v[20:23], v[212:215], v[88:91], v[20:23]
    ds_read_b64_tr_b16 v[196:197], v7 offset:24576
    ds_read_b64_tr_b16 v[198:199], v7 offset:25088
    v_mfma_f32_16x16x32_bf16 v[16:19], v[232:235], v[88:91], v[16:19]
    ds_read_b64_tr_b16 v[64:65], v7 offset:28672
    ds_read_b64_tr_b16 v[66:67], v7 offset:29184
    v_mfma_f32_16x16x32_bf16 v[16:19], v[212:215], v[184:187], v[16:19]
    ds_read_b64_tr_b16 v[136:137], v7 offset:32768
    ds_read_b64_tr_b16 v[138:139], v7 offset:33280
    s_waitcnt lgkmcnt(11)
    v_mfma_f32_16x16x32_bf16 v[48:51], v[92:95], v[116:119], v[48:51]
    s_waitcnt lgkmcnt(6)
    v_cmp_ne_u32 vcc, 0, v12
    ds_read_b64_tr_b16 v[204:205], v7 offset:36864
    ds_read_b64_tr_b16 v[206:207], v7 offset:37376
    v_mfma_f32_16x16x32_bf16 v[48:51], v[56:59], v[208:211], v[48:51]
    s_and_b32 s62, vcc_lo, 0xf0
    s_cbranch_scc1 Lck_12_slow
Lck_12_ok:
    ds_read_b64_tr_b16 v[148:149], v7 offset:40960
    ds_read_b64_tr_b16 v[150:151], v7 offset:41472
    v_mfma_f32_16x16x32_bf16 v[48:51], v[76:79], v[192:195], v[48:51]
    ds_read_b64_tr_b16 v[140:141], v7 offset:45056
    ds_read_b64_tr_b16 v[142:143], v7 offset:45568
    s_waitcnt lgkmcnt(10)
    v_mfma_f32_16x16x32_bf16 v[48:51], v[196:199], v[132:135], v[48:51]
    ds_read_b64_tr_b16 v[160:161], v7 offset:49152
    ds_read_b64_tr_b16 v[162:163], v7 offset:49664
    s_waitcnt lgkmcnt(10)
    v_mfma_f32_16x16x32_bf16 v[48:51], v[64:67], v[84:87], v[48:51]
    ds_read_b64_tr_b16 v[220:221], v6 offset:0
    ds_read_b64_tr_b16 v[222:223], v6 offset:512
    s_waitcnt lgkmcnt(10)
    v_mfma_f32_16x16x32_bf16 v[48:51], v[136:139], v[112:115], v[48:51]
    ds_read_b64_tr_b16 v[80:81], v6 offset:4096
    ds_read_b64_tr_b16 v[82:83], v6 offset:4608
    s_waitcnt lgkmcnt(10)
    v_mfma_f32_16x16x32_bf16 v[48:51], v[204:207], v[128:131], v[48:51]
    ds_read_b64_tr_b16 v[164:165], v6 offset:8192
    ds_read_b64_tr_b16 v[166:167], v6 offset:8704
    s_waitcnt lgkmcnt(10)
    v_mfma_f32_16x16x32_bf16 v[48:51], v[148:151], v[52:55], v[48:51]
    ds_read_b64_tr_b16 v[176:177], v6 offset:12288
    ds_read_b64_tr_b16 v[178:179], v6 offset:12800
    s_waitcnt lgkmcnt(10)
    v_mfma_f32_16x16x32_bf16 v[48:51], v[140:143], v[72:75], v[48:51]
    ds_read_b64_tr_b16 v[228:229], v6 offset:16384
    ds_read_b64_tr_b16 v[230:231], v6 offset:16896
    s_waitcnt lgkmcnt(10)
    v_mfma_f32_16x16x32_bf16 v[48:51], v[160:163], v[152:155], v[48:51]
    ds_read_b64_tr_b16 v[188:189], v6 offset:20480
    ds_read_b64_tr_b16 v[190:191], v6 offset:20992
    s_waitcnt lgkmcnt(10)
    v_mfma_f32_16x16x32_bf16 v[48:51], v[220:223], v[88:91], v[48:51]
    v_perm_b32 v241, v243, v242, s47
    v_perm_b32 v242, v173, v172, s47
    s_waitcnt lgkmcnt(8)
    v_mfma_f32_16x16x32_bf16 v[48:51], v[80:83], v[184:187], v[48:51]
    v_perm_b32 v243, v175, v174, s47
    v_perm_b32 v71, v239, v238, s47
    s_waitcnt lgkmcnt(6)
    v_mfma_f32_16x16x32_bf16 v[48:51], v[164:167], v[216:219], v[48:51]
    v_perm_b32 v180, v181, v180, s47
    s_waitcnt lgkmcnt(4)
    v_mfma_f32_16x16x32_bf16 v[48:51], v[176:179], v[156:159], v[48:51]
    v_perm_b32 v181, v183, v182, s47
    v_perm_b32 v182, v121, v120, s47
    s_waitcnt lgkmcnt(2)
    v_mfma_f32_16x16x32_bf16 v[48:51], v[228:231], v[68:71], v[48:51]
    v_perm_b32 v183, v123, v122, s47
    s_waitcnt lgkmcnt(0)
    v_mfma_f32_16x16x32_bf16 v[48:51], v[188:191], v[240:243], v[48:51]
    ds_read_b128 v[200:203], v4 offset:2464
    ds_read_b128 v[168:171], v4 offset:2480
    v_mfma_f32_16x16x32_bf16 v[44:47], v[92:95], v[208:211], v[44:47]
    s_nop 1
    v_mfma_f32_16x16x32_bf16 v[44:47], v[56:59], v[192:195], v[44:47]
    s_nop 1
    v_mfma_f32_16x16x32_bf16 v[44:47], v[76:79], v[132:135], v[44:47]
    s_nop 0
    v_cvt_pk_bf16_f32 v96, v48, v49
    v_cvt_pk_bf16_f32 v97, v50, v51
    v_mfma_f32_16x16x32_bf16 v[44:47], v[196:199], v[180:183], v[44:47]
    v_add_u32 v96, s50, v96
    v_add_u32 v97, s51, v97
    v_mfma_f32_16x16x32_bf16 v[44:47], v[64:67], v[112:115], v[44:47]
    v_and_or_b32 v96, v96, v10, s56
    v_and_or_b32 v97, v97, v10, s57
    v_mfma_f32_16x16x32_bf16 v[44:47], v[136:139], v[128:131], v[44:47]
    v_mfma_f32_16x16x32_bf16 v[44:47], v[204:207], v[52:55], v[44:47]
    v_mfma_f32_16x16x32_bf16 v[44:47], v[148:151], v[72:75], v[44:47]
    ds_read_b128 v[124:127], v5 offset:2112
    ds_read_b128 v[244:247], v5 offset:2128
    v_mfma_f32_16x16x32_bf16 v[44:47], v[140:143], v[152:155], v[44:47]
    v_mfma_f32_16x16x32_bf16 v[44:47], v[160:163], v[88:91], v[44:47]
    s_waitcnt lgkmcnt(2)
    v_perm_b32 v200, v201, v200, s47
    v_mfma_f32_16x16x32_bf16 v[44:47], v[220:223], v[184:187], v[44:47]
    v_perm_b32 v201, v203, v202, s47
    v_perm_b32 v202, v169, v168, s47
    v_mfma_f32_16x16x32_bf16 v[44:47], v[80:83], v[216:219], v[44:47]
    v_perm_b32 v203, v171, v170, s47
    v_mfma_f32_16x16x32_bf16 v[44:47], v[164:167], v[156:159], v[44:47]
    s_waitcnt lgkmcnt(0)
    v_perm_b32 v124, v125, v124, s47
    v_mfma_f32_16x16x32_bf16 v[44:47], v[176:179], v[68:71], v[44:47]
    v_perm_b32 v125, v127, v126, s47
    v_perm_b32 v126, v245, v244, s47
    v_mfma_f32_16x16x32_bf16 v[44:47], v[228:231], v[240:243], v[44:47]
    v_perm_b32 v127, v247, v246, s47
    v_mfma_f32_16x16x32_bf16 v[44:47], v[188:191], v[200:203], v[44:47]
    ds_read_b128 v[224:227], v4 offset:2112
    ds_read_b128 v[60:63], v4 offset:2128
    v_mfma_f32_16x16x32_bf16 v[40:43], v[92:95], v[192:195], v[40:43]
    s_nop 1
    v_mfma_f32_16x16x32_bf16 v[40:43], v[56:59], v[132:135], v[40:43]
    s_nop 1
    v_mfma_f32_16x16x32_bf16 v[40:43], v[76:79], v[180:183], v[40:43]
    s_nop 0
    v_cvt_pk_bf16_f32 v98, v44, v45
    v_cvt_pk_bf16_f32 v99, v46, v47
    v_mfma_f32_16x16x32_bf16 v[40:43], v[196:199], v[124:127], v[40:43]
    v_add_u32 v98, s50, v98
    v_add_u32 v99, s51, v99
    v_mfma_f32_16x16x32_bf16 v[40:43], v[64:67], v[128:131], v[40:43]
    v_and_or_b32 v98, v98, v10, s58
    v_and_or_b32 v99, v99, v10, s59
    v_mfma_f32_16x16x32_bf16 v[40:43], v[136:139], v[52:55], v[40:43]
    s_add_u32 s49, s48, 0
    buffer_store_dwordx4 v[96:99], v8, s[40:43], s49 offen sc1
    v_mfma_f32_16x16x32_bf16 v[40:43], v[204:207], v[72:75], v[40:43]
    v_mfma_f32_16x16x32_bf16 v[40:43], v[148:151], v[152:155], v[40:43]
    ds_read_b128 v[248:251], v5 offset:1760
    ds_read_b128 v[144:147], v5 offset:1776
    v_mfma_f32_16x16x32_bf16 v[40:43], v[140:143], v[88:91], v[40:43]
    v_mfma_f32_16x16x32_bf16 v[40:43], v[160:163], v[184:187], v[40:43]
    s_waitcnt lgkmcnt(2)
    v_perm_b32 v224, v225, v224, s47
    v_mfma_f32_16x16x32_bf16 v[40:43], v[220:223], v[216:219], v[40:43]
    v_perm_b32 v225, v227, v226, s47
    v_perm_b32 v226, v61, v60, s47
    v_mfma_f32_16x16x32_bf16 v[40:43], v[80:83], v[156:159], v[40:43]
    v_perm_b32 v227, v63, v62, s47
    v_mfma_f32_16x16x32_bf16 v[40:43], v[164:167], v[68:71], v[40:43]
    s_waitcnt lgkmcnt(0)
    v_perm_b32 v248, v249, v248, s47
    v_mfma_f32_16x16x32_bf16 v[40:43], v[176:179], v[240:243], v[40:43]
    v_perm_b32 v249, v251, v250, s47
    v_perm_b32 v250, v145, v144, s47
    v_mfma_f32_16x16x32_bf16 v[40:43], v[228:231], v[200:203], v[40:43]
    v_perm_b32 v251, v147, v146, s47
    v_mfma_f32_16x16x32_bf16 v[40:43], v[188:191], v[224:227], v[40:43]
    ds_read_b128 v[232:235], v4 offset:1760
    ds_read_b128 v[212:215], v4 offset:1776
    v_mfma_f32_16x16x32_bf16 v[36:39], v[92:95], v[132:135], v[36:39]
    s_nop 1
    v_mfma_f32_16x16x32_bf16 v[36:39], v[56:59], v[180:183], v[36:39]
    s_nop 1
    v_mfma_f32_16x16x32_bf16 v[36:39], v[76:79], v[124:127], v[36:39]
    s_nop 0
    v_cvt_pk_bf16_f32 v116, v40, v41
    v_cvt_pk_bf16_f32 v117, v42, v43
    v_mfma_f32_16x16x32_bf16 v[36:39], v[196:199], v[248:251], v[36:39]
    v_add_u32 v116, s50, v116
    v_add_u32 v117, s51, v117
    v_mfma_f32_16x16x32_bf16 v[36:39], v[64:67], v[52:55], v[36:39]
    v_and_or_b32 v116, v116, v10, s56
    v_and_or_b32 v117, v117, v10, s57
    v_mfma_f32_16x16x32_bf16 v[36:39], v[136:139], v[72:75], v[36:39]
    v_mfma_f32_16x16x32_bf16 v[36:39], v[204:207], v[152:155], v[36:39]
    v_mfma_f32_16x16x32_bf16 v[36:39], v[148:151], v[88:91], v[36:39]
    ds_read_b128 v[84:87], v5 offset:1408
    ds_read_b128 v[172:175], v5 offset:1424
    v_mfma_f32_16x16x32_bf16 v[36:39], v[140:143], v[184:187], v[36:39]
    v_mfma_f32_16x16x32_bf16 v[36:39], v[160:163], v[216:219], v[36:39]
    s_waitcnt lgkmcnt(2)
    v_perm_b32 v232, v233, v232, s47
    v_mfma_f32_16x16x32_bf16 v[36:39], v[220:223], v[156:159], v[36:39]
    v_perm_b32 v233, v235, v234, s47
    v_perm_b32 v234, v213, v212, s47
    v_mfma_f32_16x16x32_bf16 v[36:39], v[80:83], v[68:71], v[36:39]
    v_perm_b32 v235, v215, v214, s47
    v_mfma_f32_16x16x32_bf16 v[36:39], v[164:167], v[240:243], v[36:39]
    s_waitcnt lgkmcnt(0)
    v_perm_b32 v84, v85, v84, s47
    v_mfma_f32_16x16x32_bf16 v[36:39], v[176:179], v[200:203], v[36:39]
    v_perm_b32 v85, v87, v86, s47
    v_perm_b32 v86, v173, v172, s47
    v_mfma_f32_16x16x32_bf16 v[36:39], v[228:231], v[224:227], v[36:39]
    v_perm_b32 v87, v175, v174, s47
    v_mfma_f32_16x16x32_bf16 v[36:39], v[188:191], v[232:235], v[36:39]
    ds_read_b128 v[236:239], v4 offset:1408
    ds_read_b128 v[120:123], v4 offset:1424
    v_mfma_f32_16x16x32_bf16 v[32:35], v[92:95], v[180:183], v[32:35]
    s_nop 1
    v_mfma_f32_16x16x32_bf16 v[32:35], v[56:59], v[124:127], v[32:35]
    s_nop 1
    v_mfma_f32_16x16x32_bf16 v[32:35], v[76:79], v[248:251], v[32:35]
    s_nop 0
    v_cvt_pk_bf16_f32 v118, v36, v37
    v_cvt_pk_bf16_f32 v119, v38, v39
    v_mfma_f32_16x16x32_bf16 v[32:35], v[196:199], v[84:87], v[32:35]
    v_add_u32 v118, s50, v118
    v_add_u32 v119, s51, v119
    v_mfma_f32_16x16x32_bf16 v[32:35], v[64:67], v[72:75], v[32:35]
    v_and_or_b32 v118, v118, v10, s58
    v_and_or_b32 v119, v119, v10, s59
    v_mfma_f32_16x16x32_bf16 v[32:35], v[136:139], v[152:155], v[32:35]
    s_add_u32 s49, s48, 73728
    buffer_store_dwordx4 v[116:119], v8, s[40:43], s49 offen sc1
    v_mfma_f32_16x16x32_bf16 v[32:35], v[204:207], v[88:91], v[32:35]
    v_mfma_f32_16x16x32_bf16 v[32:35], v[148:151], v[184:187], v[32:35]
    ds_read_b128 v[208:211], v5 offset:1056
    ds_read_b128 v[112:115], v5 offset:1072
    v_mfma_f32_16x16x32_bf16 v[32:35], v[140:143], v[216:219], v[32:35]
    v_mfma_f32_16x16x32_bf16 v[32:35], v[160:163], v[156:159], v[32:35]
    s_waitcnt lgkmcnt(2)
    v_perm_b32 v236, v237, v236, s47
    v_mfma_f32_16x16x32_bf16 v[32:35], v[220:223], v[68:71], v[32:35]
    v_perm_b32 v237, v239, v238, s47
    v_perm_b32 v238, v121, v120, s47
    v_mfma_f32_16x16x32_bf16 v[32:35], v[80:83], v[240:243], v[32:35]
    v_perm_b32 v239, v123, v122, s47
    v_mfma_f32_16x16x32_bf16 v[32:35], v[164:167], v[200:203], v[32:35]
    s_waitcnt lgkmcnt(0)
    v_perm_b32 v208, v209, v208, s47
    v_mfma_f32_16x16x32_bf16 v[32:35], v[176:179], v[224:227], v[32:35]
    v_perm_b32 v209, v211, v210, s47
    v_perm_b32 v210, v113, v112, s47
    v_mfma_f32_16x16x32_bf16 v[32:35], v[228:231], v[232:235], v[32:35]
    v_perm_b32 v211, v115, v114, s47
    v_mfma_f32_16x16x32_bf16 v[32:35], v[188:191], v[236:239], v[32:35]
    ds_read_b128 v[168:171], v4 offset:1056
    ds_read_b128 v[244:247], v4 offset:1072
    v_mfma_f32_16x16x32_bf16 v[28:31], v[92:95], v[124:127], v[28:31]
    s_nop 1
    v_mfma_f32_16x16x32_bf16 v[28:31], v[56:59], v[248:251], v[28:31]
    s_nop 1
    v_mfma_f32_16x16x32_bf16 v[28:31], v[76:79], v[84:87], v[28:31]
    s_nop 0
    v_cvt_pk_bf16_f32 v192, v32, v33
    v_cvt_pk_bf16_f32 v193, v34, v35
    v_mfma_f32_16x16x32_bf16 v[28:31], v[196:199], v[208:211], v[28:31]
    v_add_u32 v192, s50, v192
    v_add_u32 v193, s51, v193
    v_mfma_f32_16x16x32_bf16 v[28:31], v[64:67], v[152:155], v[28:31]
    v_and_or_b32 v192, v192, v10, s56
    v_and_or_b32 v193, v193, v10, s57
    v_mfma_f32_16x16x32_bf16 v[28:31], v[136:139], v[88:91], v[28:31]
    v_mfma_f32_16x16x32_bf16 v[28:31], v[204:207], v[184:187], v[28:31]
    v_mfma_f32_16x16x32_bf16 v[28:31], v[148:151], v[216:219], v[28:31]
    ds_read_b128 v[128:131], v5 offset:704
    ds_read_b128 v[60:63], v5 offset:720
    v_mfma_f32_16x16x32_bf16 v[28:31], v[140:143], v[156:159], v[28:31]
    v_mfma_f32_16x16x32_bf16 v[28:31], v[160:163], v[68:71], v[28:31]
    s_waitcnt lgkmcnt(2)
    v_perm_b32 v168, v169, v168, s47
    v_mfma_f32_16x16x32_bf16 v[28:31], v[220:223], v[240:243], v[28:31]
    v_perm_b32 v169, v171, v170, s47
    v_perm_b32 v170, v245, v244, s47
L_pad1:
    s_cbranch_execz L_padret1
    v_mfma_f32_16x16x32_bf16 v[28:31], v[80:83], v[200:203], v[28:31]
    v_perm_b32 v171, v247, v246, s47
    v_mfma_f32_16x16x32_bf16 v[28:31], v[164:167], v[224:227], v[28:31]
    s_waitcnt lgkmcnt(0)
    v_perm_b32 v128, v129, v128, s47
    v_mfma_f32_16x16x32_bf16 v[28:31], v[176:179], v[232:235], v[28:31]
    v_perm_b32 v129, v131, v130, s47
    v_perm_b32 v130, v61, v60, s47
    v_mfma_f32_16x16x32_bf16 v[28:31], v[228:231], v[236:239], v[28:31]
    v_perm_b32 v131, v63, v62, s47
    v_mfma_f32_16x16x32_bf16 v[28:31], v[188:191], v[168:171], v[28:31]
    ds_read_b128 v[144:147], v4 offset:704
    ds_read_b128 v[132:135], v4 offset:720
    v_mfma_f32_16x16x32_bf16 v[24:27], v[92:95], v[248:251], v[24:27]
    s_nop 1
    v_mfma_f32_16x16x32_bf16 v[24:27], v[56:59], v[84:87], v[24:27]
    s_nop 1
    v_mfma_f32_16x16x32_bf16 v[24:27], v[76:79], v[208:211], v[24:27]
    s_nop 0
    v_cvt_pk_bf16_f32 v194, v28, v29
    v_cvt_pk_bf16_f32 v195, v30, v31
    v_mfma_f32_16x16x32_bf16 v[24:27], v[196:199], v[128:131], v[24:27]
    v_add_u32 v194, s50, v194
    v_add_u32 v195, s51, v195
    v_mfma_f32_16x16x32_bf16 v[24:27], v[64:67], v[88:91], v[24:27]
    v_and_or_b32 v194, v194, v10, s58
    v_and_or_b32 v195, v195, v10, s59
    v_mfma_f32_16x16x32_bf16 v[24:27], v[136:139], v[184:187], v[24:27]
    s_add_u32 s49, s48, 147456
    buffer_store_dwordx4 v[192:195], v8, s[40:43], s49 offen sc1
    s_waitcnt vmcnt(2)
    s_mov_b64 exec, 1
    ds_add_u32 v2, v1
    s_mov_b64 exec, -1
    v_mfma_f32_16x16x32_bf16 v[24:27], v[204:207], v[216:219], v[24:27]
    v_mfma_f32_16x16x32_bf16 v[24:27], v[148:151], v[156:159], v[24:27]
    ds_read_b128 v[52:55], v5 offset:352
    ds_read_b128 v[212:215], v5 offset:368
    v_mfma_f32_16x16x32_bf16 v[24:27], v[140:143], v[68:71], v[24:27]
    v_mfma_f32_16x16x32_bf16 v[24:27], v[160:163], v[240:243], v[24:27]
    s_waitcnt lgkmcnt(3)
    v_perm_b32 v144, v145, v144, s47
    v_mfma_f32_16x16x32_bf16 v[24:27], v[220:223], v[200:203], v[24:27]
    v_perm_b32 v145, v147, v146, s47
    v_perm_b32 v146, v133, v132, s47
    v_mfma_f32_16x16x32_bf16 v[24:27], v[80:83], v[224:227], v[24:27]
    v_perm_b32 v147, v135, v134, s47
    v_mfma_f32_16x16x32_bf16 v[24:27], v[164:167], v[232:235], v[24:27]
    s_waitcnt lgkmcnt(0)
    v_perm_b32 v52, v53, v52, s47
    v_mfma_f32_16x16x32_bf16 v[24:27], v[176:179], v[236:239], v[24:27]
    v_perm_b32 v53, v55, v54, s47
    v_perm_b32 v54, v213, v212, s47
    v_mfma_f32_16x16x32_bf16 v[24:27], v[228:231], v[168:171], v[24:27]
    v_perm_b32 v55, v215, v214, s47
    v_mfma_f32_16x16x32_bf16 v[24:27], v[188:191], v[144:147], v[24:27]
    ds_read_b128 v[172:175], v4 offset:352
    ds_read_b128 v[180:183], v4 offset:368
    v_mfma_f32_16x16x32_bf16 v[20:23], v[92:95], v[84:87], v[20:23]
    s_nop 1
    v_mfma_f32_16x16x32_bf16 v[20:23], v[56:59], v[208:211], v[20:23]
    s_nop 1
    v_mfma_f32_16x16x32_bf16 v[20:23], v[76:79], v[128:131], v[20:23]
    s_nop 0
    v_cvt_pk_bf16_f32 v72, v24, v25
    v_cvt_pk_bf16_f32 v73, v26, v27
    v_mfma_f32_16x16x32_bf16 v[20:23], v[196:199], v[52:55], v[20:23]
    v_add_u32 v72, s50, v72
    v_add_u32 v73, s51, v73
    v_mfma_f32_16x16x32_bf16 v[20:23], v[64:67], v[184:187], v[20:23]
    v_and_or_b32 v72, v72, v10, s56
    v_and_or_b32 v73, v73, v10, s57
    v_mfma_f32_16x16x32_bf16 v[20:23], v[136:139], v[216:219], v[20:23]
    v_mfma_f32_16x16x32_bf16 v[20:23], v[204:207], v[156:159], v[20:23]
    v_mfma_f32_16x16x32_bf16 v[20:23], v[148:151], v[68:71], v[20:23]
    ds_read_b128 v[120:123], v5 offset:0
    ds_read_b128 v[112:115], v5 offset:16
    v_mfma_f32_16x16x32_bf16 v[20:23], v[140:143], v[240:243], v[20:23]
    v_mfma_f32_16x16x32_bf16 v[20:23], v[160:163], v[200:203], v[20:23]
    s_waitcnt lgkmcnt(2)
    v_perm_b32 v172, v173, v172, s47
    v_mfma_f32_16x16x32_bf16 v[20:23], v[220:223], v[224:227], v[20:23]
    v_perm_b32 v173, v175, v174, s47
    v_perm_b32 v174, v181, v180, s47
    v_mfma_f32_16x16x32_bf16 v[20:23], v[80:83], v[232:235], v[20:23]
    v_perm_b32 v175, v183, v182, s47
    v_mfma_f32_16x16x32_bf16 v[20:23], v[164:167], v[236:239], v[20:23]
    s_waitcnt lgkmcnt(0)
    v_perm_b32 v120, v121, v120, s47
    v_mfma_f32_16x16x32_bf16 v[20:23], v[176:179], v[168:171], v[20:23]
    v_perm_b32 v121, v123, v122, s47
    v_perm_b32 v122, v113, v112, s47
    v_mfma_f32_16x16x32_bf16 v[20:23], v[228:231], v[144:147], v[20:23]
    v_perm_b32 v123, v115, v114, s47
    v_mfma_f32_16x16x32_bf16 v[20:23], v[188:191], v[172:175], v[20:23]
    ds_read_b128 v[124:127], v4 offset:0
    ds_read_b128 v[152:155], v4 offset:16
    v_mfma_f32_16x16x32_bf16 v[16:19], v[92:95], v[208:211], v[16:19]
    s_nop 1
    v_mfma_f32_16x16x32_bf16 v[16:19], v[56:59], v[128:131], v[16:19]
    s_nop 1
    v_mfma_f32_16x16x32_bf16 v[16:19], v[76:79], v[52:55], v[16:19]
    s_nop 0
    v_cvt_pk_bf16_f32 v74, v20, v21
    v_cvt_pk_bf16_f32 v75, v22, v23
    v_mfma_f32_16x16x32_bf16 v[16:19], v[196:199], v[120:123], v[16:19]
    v_add_u32 v74, s50, v74
    v_add_u32 v75, s51, v75
    v_mfma_f32_16x16x32_bf16 v[16:19], v[64:67], v[216:219], v[16:19]
    v_and_or_b32 v74, v74, v10, s58
    v_and_or_b32 v75, v75, v10, s59
    v_mfma_f32_16x16x32_bf16 v[16:19], v[136:139], v[156:159], v[16:19]
    s_add_u32 s49, s48, 221184
    buffer_store_dwordx4 v[72:75], v8, s[40:43], s49 offen sc1
    s_waitcnt vmcnt(2)
    s_mov_b64 exec, 1
    ds_add_u32 v2, v1
    s_mov_b64 exec, -1
    v_mfma_f32_16x16x32_bf16 v[16:19], v[204:207], v[68:71], v[16:19]
    v_mfma_f32_16x16x32_bf16 v[16:19], v[148:151], v[240:243], v[16:19]
    v_mfma_f32_16x16x32_bf16 v[16:19], v[140:143], v[200:203], v[16:19]
    v_mfma_f32_16x16x32_bf16 v[16:19], v[160:163], v[224:227], v[16:19]
    v_mfma_f32_16x16x32_bf16 v[16:19], v[220:223], v[232:235], v[16:19]
    s_waitcnt lgkmcnt(1)
    v_perm_b32 v124, v125, v124, s47
    v_mfma_f32_16x16x32_bf16 v[16:19], v[80:83], v[236:239], v[16:19]
    v_perm_b32 v125, v127, v126, s47
    v_perm_b32 v126, v153, v152, s47
    v_mfma_f32_16x16x32_bf16 v[16:19], v[164:167], v[168:171], v[16:19]
    v_perm_b32 v127, v155, v154, s47
    v_mfma_f32_16x16x32_bf16 v[16:19], v[176:179], v[144:147], v[16:19]
    v_mfma_f32_16x16x32_bf16 v[16:19], v[228:231], v[172:175], v[16:19]
    v_mfma_f32_16x16x32_bf16 v[16:19], v[188:191], v[124:127], v[16:19]
    s_add_u32 s49, s48, 294912
    s_nop 6
    v_cvt_pk_bf16_f32 v248, v16, v17
    v_cvt_pk_bf16_f32 v249, v18, v19
    v_add_u32 v248, s50, v248
    v_add_u32 v249, s51, v249
    v_and_or_b32 v248, v248, v10, v254
    v_and_or_b32 v249, v249, v10, v255
    buffer_store_dwordx2 v[248:249], v9, s[40:43], s49 offen sc1
    s_cmp_eq_u32 s16, 0
    s_cbranch_scc1 Lz_start
Lsp2:
    ds_read_b32 v12, v3 offset:416
    s_waitcnt lgkmcnt(0)
    v_cmp_ne_u32 vcc, 0, v12
    s_and_b32 s62, vcc_lo, 0xf0
    s_cbranch_scc1 Lsp2
    ds_read_b64_tr_b16 v[120:121], v14 offset:0
    ds_read_b64_tr_b16 v[122:123], v14 offset:4608
    ds_read_b64_tr_b16 v[124:125], v14 offset:9216
    ds_read_b64_tr_b16 v[126:127], v14 offset:13824
    ds_read_b64_tr_b16 v[128:129], v14 offset:18432
    ds_read_b64_tr_b16 v[130:131], v14 offset:23040
    ds_read_b64_tr_b16 v[132:133], v14 offset:27648
    ds_read_b64_tr_b16 v[134:135], v14 offset:32256
    ds_read_b64_tr_b16 v[136:137], v14 offset:36864
    s_cmp_lg_u32 s16, 1
    s_cbranch_scc1 L_c1
    ds_read_b64_tr_b16 v[160:161], v14 offset:224
    ds_read_b64_tr_b16 v[162:163], v14 offset:4832
    ds_read_b64_tr_b16 v[164:165], v14 offset:9440
    ds_read_b64_tr_b16 v[166:167], v14 offset:14048
    ds_read_b64_tr_b16 v[168:169], v14 offset:18656
    ds_read_b64_tr_b16 v[170:171], v14 offset:23264
    ds_read_b64_tr_b16 v[172:173], v14 offset:27872
    ds_read_b64_tr_b16 v[174:175], v14 offset:32480
    ds_read_b64_tr_b16 v[176:177], v14 offset:37088
L_c1:
    s_waitcnt vmcnt(2)
    s_mov_b64 exec, 1
    ds_add_u32 v2, v1
    s_mov_b64 exec, -1
    s_waitcnt vmcnt(1)
    s_mov_b64 exec, 1
    ds_add_u32 v2, v1
    s_mov_b64 exec, -1
    s_waitcnt vmcnt(0)
    s_mov_b64 exec, 1
    ds_add_u32 v2, v1
    s_mov_b64 exec, -1
    s_branch L_zbar
Lz_start:
    s_branch Lsp3_in
Lsp3:
    s_sleep 1
Lsp3_in:
    ds_read_b32 v112, v3 offset:768
    s_waitcnt lgkmcnt(0)
    v_cmp_gt_u32 vcc, s9, v112
    s_and_b32 s62, vcc_lo, 0xe
    s_cbranch_scc1 Lsp3
    s_mov_b32 s60, 0
Lz_poll:
    s_cmp_eq_u32 s5, 4
    s_cbranch_scc1 Lz_one
    buffer_load_dwordx4 v[44:47], v108, s[40:43], s10 offen offset:1024 sc1
    buffer_load_dwordx4 v[52:55], v108, s[40:43], s11 offen offset:1024 sc1
    buffer_load_dwordx4 v[40:43], v108, s[40:43], s10 offen sc1
    buffer_load_dwordx4 v[48:51], v108, s[40:43], s11 offen sc1
Lz_dry:
    s_waitcnt vmcnt(3)
    v_xor_b32 v44, s56, v44
    v_xor_b32 v45, s57, v45
    v_xor_b32 v46, s58, v46
    v_xor_b32 v47, s59, v47
    v_or3_b32 v64, v44, v45, v46
    v_or_b32 v64, v64, v47
    v_mfma_f32_16x16x32_bf16 v[56:59], v[104:107], v[44:47], 0
    s_waitcnt vmcnt(2)
    v_xor_b32 v52, s56, v52
    v_xor_b32 v53, s57, v53
    v_xor_b32 v54, s58, v54
    v_xor_b32 v55, s59, v55
    v_or3_b32 v64, v64, v52, v53
    v_or3_b32 v64, v64, v54, v55
    v_mfma_f32_16x16x32_bf16 v[60:63], v[104:107], v[52:55], 0
Lz_common:
    s_waitcnt vmcnt(1)
    v_xor_b32 v40, s56, v40
    v_xor_b32 v41, s57, v41
    v_xor_b32 v42, s58, v42
    v_xor_b32 v43, s59, v43
    v_or3_b32 v64, v64, v40, v41
    v_or3_b32 v64, v64, v42, v43
    v_mfma_f32_16x16x32_bf16 v[56:59], v[100:103], v[40:43], v[56:59]
    s_waitcnt vmcnt(0)
    v_xor_b32 v48, s56, v48
    v_xor_b32 v49, s57, v49
    v_xor_b32 v50, s58, v50
    v_xor_b32 v51, s59, v51
    v_or3_b32 v64, v64, v48, v49
    v_or3_b32 v64, v64, v50, v51
    v_mfma_f32_16x16x32_bf16 v[60:63], v[100:103], v[48:51], v[60:63]
    v_and_b32 v64, s4, v64
    v_cmp_ne_u32 vcc, 0, v64
    s_cbranch_vccnz Lz_retry
Lz_go:
    v_mul_f32 v56, s6, v56
    v_mul_f32 v57, s6, v57
    v_mul_f32 v58, s6, v58
    v_mul_f32 v59, s6, v59
    v_med3_f32 v56, v56, -v110, v110
    v_med3_f32 v57, v57, -v110, v110
    v_med3_f32 v58, v58, -v110, v110
    v_med3_f32 v59, v59, -v110, v110
    v_exp_f32 v56, v56
    v_mul_f32 v60, s7, v60
    v_exp_f32 v57, v57
    v_mul_f32 v61, s7, v61
    v_exp_f32 v58, v58
    v_mul_f32 v62, s7, v62
    v_exp_f32 v59, v59
    v_mul_f32 v63, s7, v63
    v_exp_f32 v60, v60
    v_exp_f32 v61, v61
    v_exp_f32 v62, v62
    v_exp_f32 v63, v63
    s_nop 0
    v_add_f32 v60, 1.0, v60
    v_add_f32 v61, 1.0, v61
    v_add_f32 v62, 1.0, v62
    v_add_f32 v63, 1.0, v63
    v_fma_f32 v60, v56, v60, v60
    v_fma_f32 v61, v57, v61, v61
    v_fma_f32 v62, v58, v62, v62
    v_fma_f32 v63, v59, v63, v63
    v_rcp_f32 v60, v60
    v_add_f32 v56, -1.0, v56
    v_rcp_f32 v61, v61
    v_add_f32 v57, -1.0, v57
    v_rcp_f32 v62, v62
    v_add_f32 v58, -1.0, v58
    v_rcp_f32 v63, v63
    v_add_f32 v59, -1.0, v59
    v_mul_f32 v56, v56, v60
    v_mul_f32 v57, v57, v61
    v_mul_f32 v58, v58, v62
    v_mul_f32 v59, v59, v63
    v_cvt_pk_bf16_f32 v44, v56, v57
    v_cvt_pk_bf16_f32 v45, v58, v59
    s_cmp_eq_u32 s4, 0
    s_cbranch_scc1 Lz_nobar
    s_mov_b32 exec_hi, s8
    ds_write_b64 v109, v[44:45]
    s_mov_b64 exec, -1
L_zbar:
    s_waitcnt lgkmcnt(0)
    s_barrier
Lz_nobar:
    ds_read_b64 v[156:157], v13 offset:2048
    ds_read_b128 v[140:143], v13 offset:0
    ds_read_b128 v[144:147], v13 offset:512
    ds_read_b128 v[148:151], v13 offset:1024
    ds_read_b128 v[152:155], v13 offset:1536
    s_cmp_eq_u32 s4, 0
    s_cselect_b32 s62, 1, s16
    s_cmp_lg_u32 s62, 1
    s_cbranch_scc0 L_g2
L_g1:
    s_waitcnt lgkmcnt(4)
    v_mfma_f32_16x16x16_bf16 v[56:59], v[136:137], v[156:157], 0
    s_nop 3
    s_waitcnt lgkmcnt(3)
    s_nop 0
    v_mfma_f32_16x16x32_bf16 v[56:59], v[120:123], v[140:143], v[56:59]
    s_waitcnt lgkmcnt(2)
    v_mfma_f32_16x16x32_bf16 v[56:59], v[124:127], v[144:147], v[56:59]
    s_waitcnt lgkmcnt(1)
    v_mfma_f32_16x16x32_bf16 v[56:59], v[128:131], v[148:151], v[56:59]
    s_waitcnt lgkmcnt(0)
    v_mfma_f32_16x16x32_bf16 v[56:59], v[132:135], v[152:155], v[56:59]
    s_nop 7
    v_cvt_pk_bf16_f32 v44, v56, v57
    v_cvt_pk_bf16_f32 v45, v58, v59
    s_cmp_eq_u32 s4, 0
    s_cbranch_scc1 Lz_dryend
    buffer_store_dwordx2 v[44:45], v15, s[36:39], 0 offen sc0 sc1
    s_lshl_b32 s96, s17, 3
    s_add_u32 s96, s96, s16
    s_cmp_lg_u32 s96, 2
    s_cbranch_scc1 L_fin2
    v_mov_b32 v46, s63
    v_mov_b32 v47, s52
    s_mov_b64 exec, 1
    buffer_store_dword v46, v47, s[40:43], 0 offen sc0 sc1
    s_mov_b64 exec, -1
L_fin2:
    s_endpgm
L_g2:
    s_waitcnt lgkmcnt(4)
    v_mfma_f32_16x16x16_bf16 v[68:71], v[176:177], v[156:157], 0
    s_nop 3
    s_waitcnt lgkmcnt(3)
    s_nop 0
    v_mfma_f32_16x16x32_bf16 v[68:71], v[160:163], v[140:143], v[68:71]
    s_waitcnt lgkmcnt(2)
    v_mfma_f32_16x16x32_bf16 v[68:71], v[164:167], v[144:147], v[68:71]
    s_waitcnt lgkmcnt(1)
    v_mfma_f32_16x16x32_bf16 v[68:71], v[168:171], v[148:151], v[68:71]
    s_waitcnt lgkmcnt(0)
    v_mfma_f32_16x16x32_bf16 v[68:71], v[172:175], v[152:155], v[68:71]
    v_mfma_f32_16x16x16_bf16 v[56:59], v[136:137], v[156:157], 0
    s_nop 5
    v_mfma_f32_16x16x32_bf16 v[56:59], v[120:123], v[140:143], v[56:59]
    v_cvt_pk_bf16_f32 v46, v68, v69
    v_mfma_f32_16x16x32_bf16 v[56:59], v[124:127], v[144:147], v[56:59]
    v_cvt_pk_bf16_f32 v47, v70, v71
    v_mfma_f32_16x16x32_bf16 v[56:59], v[128:131], v[148:151], v[56:59]
    s_cmp_eq_u32 s4, 0
    s_cbranch_scc1 L_g1
    v_mfma_f32_16x16x32_bf16 v[56:59], v[132:135], v[152:155], v[56:59]
    buffer_store_dwordx2 v[46:47], v15, s[36:39], 0 offen offset:224 sc0 sc1
    s_nop 6
    v_cvt_pk_bf16_f32 v44, v56, v57
    v_cvt_pk_bf16_f32 v45, v58, v59
    buffer_store_dwordx2 v[44:45], v15, s[36:39], 0 offen sc0 sc1
    s_endpgm
Lz_one:
    buffer_load_dwordx4 v[40:43], v108, s[40:43], s10 offen sc1
    buffer_load_dwordx4 v[48:51], v108, s[40:43], s11 offen sc1
    v_mov_b32 v56, 0
    v_mov_b32 v57, 0
    v_mov_b32 v58, 0
    v_mov_b32 v59, 0
    v_mov_b32 v60, 0
    v_mov_b32 v61, 0
    v_mov_b32 v62, 0
    v_mov_b32 v63, 0
    v_mov_b32 v64, 0
Lsp4:
    ds_read_b32 v12, v3 offset:416
    s_waitcnt lgkmcnt(0)
    v_cmp_ne_u32 vcc, 0, v12
    s_and_b32 s62, vcc_lo, 0xf0
    s_cbranch_scc1 Lsp4
    ds_read_b64_tr_b16 v[120:121], v14 offset:0
    ds_read_b64_tr_b16 v[122:123], v14 offset:4608
    ds_read_b64_tr_b16 v[124:125], v14 offset:9216
    ds_read_b64_tr_b16 v[126:127], v14 offset:13824
    ds_read_b64_tr_b16 v[128:129], v14 offset:18432
    ds_read_b64_tr_b16 v[130:131], v14 offset:23040
    ds_read_b64_tr_b16 v[132:133], v14 offset:27648
    ds_read_b64_tr_b16 v[134:135], v14 offset:32256
    ds_read_b64_tr_b16 v[136:137], v14 offset:36864
    s_branch Lz_common
Lz_retry:
    s_add_u32 s60, s60, 1
    s_cmp_ge_u32 s60, 3000
    s_cbranch_scc1 Lz_go
    s_sleep 4
    s_branch Lz_poll
L_loader2:
    s_waitcnt lgkmcnt(0)
    s_add_u32 s63, s63, 1
    s_add_u32 s96, s63, 0
    s_and_b32 s97, s96, 1
    s_and_b32 s96, s96, 2
    s_lshl_b32 s96, s96, 15
    s_or_b32 s56, s96, s97
    s_add_u32 s96, s63, 1
    s_and_b32 s97, s96, 1
    s_and_b32 s96, s96, 2
    s_lshl_b32 s96, s96, 15
    s_or_b32 s57, s96, s97
    s_add_u32 s96, s63, 2
    s_and_b32 s97, s96, 1
    s_and_b32 s96, s96, 2
    s_lshl_b32 s96, s96, 15
    s_or_b32 s58, s96, s97
    s_add_u32 s96, s63, 3
    s_and_b32 s97, s96, 1
    s_and_b32 s96, s96, 2
    s_lshl_b32 s96, s96, 15
    s_or_b32 s59, s96, s97
    s_mul_i32 s47, s47, 331776
    s_lshl_b32 s50, s19, 7
    s_add_u32 s47, s47, s50
    s_add_u32 s47, s47, 73728
    v_and_b32 v3, 15, v0
    v_lshlrev_b32 v3, 2, v3
    v_add_u32 v3, 38720, v3
    v_lshlrev_b32 v2, 2, v1
    v_add_u32 v2, 39488, v2
    s_add_u32 m0, s48, 16384
    s_add_u32 s50, s46, 331776
    buffer_load_dwordx4 v4, s[28:31], s50 offen  lds
    s_add_u32 m0, s61, 96
    s_mov_b64 exec, 1
    global_load_lds_dword v252, s[12:13]
    s_mov_b64 exec, -1
    s_add_u32 m0, s48, 20480
    s_add_u32 s50, s46, 414720
    buffer_load_dwordx4 v4, s[28:31], s50 offen  lds
    v_mul_u32_u24 v8, 47, v0
    v_lshrrev_b32 v8, 9, v8
    v_mul_u32_u24 v9, 11, v8
    v_sub_u32 v9, v0, v9
    v_mul_u32_u24 v8, 288, v8
    v_lshl_add_u32 v8, v9, 4, v8
    s_mul_i32 s51, s22, 144
    s_mul_i32 s52, s45, 5
    s_sub_u32 s52, s51, s52
    s_sub_u32 s52, s52, 20
    s_mul_i32 s52, s52, 288
    s_mul_i32 s53, s20, 160
    s_add_u32 s52, s52, s53
    s_sub_u32 s52, s52, 32
    v_add_u32 v8, s52, v8
    s_mul_i32 s54, s45, 880
    s_sub_u32 s54, 9680, s54
    s_mov_b32 s26, 288000
    s_mov_b32 s27, 0x20000
    s_mul_i32 s23, s21, 288000
    s_add_u32 s24, s4, s23
    s_addc_u32 s25, s5, 0
    s_mov_b32 exec_lo, 0xffdffbff
    s_mov_b32 exec_hi, 0x3ff7fe
    s_sub_u32 m0, s54, 0
    v_subrev_u32 v9, 0, v8
    buffer_load_dwordx4 v9, s[24:27], 0 offen  lds
    s_sub_u32 m0, s54, 3520
    v_subrev_u32 v9, 5760, v8
    buffer_load_dwordx4 v9, s[24:27], 0 offen  lds
    s_sub_u32 m0, s54, 7040
    v_subrev_u32 v9, 11520, v8
    s_cmp_ge_u32 s45, 2
    s_cbranch_scc1 L_xskip
    buffer_load_dwordx4 v9, s[24:27], 0 offen  lds
L_xskip:
    s_mov_b64 exec, -1
    s_add_u32 m0, s48, 24576
    s_add_u32 s50, s46, 497664
    buffer_load_dwordx4 v4, s[28:31], s50 offen  lds
    s_add_u32 m0, s61, 128
    s_mov_b64 exec, 1
    global_load_lds_dword v252, s[12:13]
    s_mov_b64 exec, -1
    s_add_u32 m0, s48, 28672
    s_add_u32 s50, s46, 580608
    buffer_load_dwordx4 v4, s[28:31], s50 offen  lds
    s_add_u32 m0, s48, 32768
    s_add_u32 s50, s46, 663552
    buffer_load_dwordx4 v4, s[28:31], s50 offen  lds
    s_add_u32 m0, s61, 160
    s_mov_b64 exec, 1
    global_load_lds_dword v252, s[12:13]
    s_mov_b64 exec, -1
    s_add_u32 m0, s48, 36864
    s_add_u32 s50, s46, 746496
    buffer_load_dwordx4 v4, s[28:31], s50 offen  lds
    s_add_u32 m0, s48, 40960
    s_add_u32 s50, s46, 829440
    buffer_load_dwordx4 v4, s[28:31], s50 offen  lds
    s_add_u32 m0, s61, 192
    s_mov_b64 exec, 1
    global_load_lds_dword v252, s[12:13]
    s_mov_b64 exec, -1
    s_add_u32 m0, s48, 45056
    s_add_u32 s50, s46, 912384
    buffer_load_dwordx4 v4, s[28:31], s50 offen  lds
    s_add_u32 m0, s48, 49152
    s_add_u32 s50, s46, 995328
    buffer_load_dwordx4 v4, s[28:31], s50 offen  lds
    s_add_u32 m0, s61, 224
    s_mov_b64 exec, 1
    global_load_lds_dword v252, s[12:13]
    s_mov_b64 exec, -1
    s_add_u32 m0, s48, 53248
    s_add_u32 s50, s46, 1078272
    buffer_load_dwordx4 v4, s[28:31], s50 offen  lds
    s_add_u32 m0, s48, 57344
    s_add_u32 s50, s46, 1161216
    buffer_load_dwordx4 v4, s[28:31], s50 offen  lds
    s_add_u32 m0, s61, 256
    s_mov_b64 exec, 1
    global_load_lds_dword v252, s[12:13]
    s_mov_b64 exec, -1
    s_add_u32 m0, s48, 61440
    s_add_u32 s50, s46, 1244160
    buffer_load_dwordx4 v4, s[28:31], s50 offen  lds
    s_add_u32 m0, s48, 65536
    s_add_u32 s50, s46, 1327104
    buffer_load_dwordx4 v4, s[28:31], s50 offen  lds
    s_add_u32 m0, s61, 288
    s_mov_b64 exec, 1
    global_load_lds_dword v252, s[12:13]
    s_mov_b64 exec, -1
    s_add_u32 m0, s48, 69632
    s_add_u32 s50, s46, 1410048
    buffer_load_dwordx4 v4, s[28:31], s50 offen  lds
    s_add_u32 m0, s48, 73728
    s_add_u32 s50, s46, 1492992
    buffer_load_dwordx4 v4, s[28:31], s50 offen  lds
    s_add_u32 m0, s61, 320
    s_mov_b64 exec, 1
    global_load_lds_dword v252, s[12:13]
    s_mov_b64 exec, -1
    s_add_u32 m0, s48, 77824
    s_add_u32 s50, s47, 0
    buffer_load_dwordx4 v4, s[28:31], s50 offen  lds
    s_add_u32 m0, s48, 81920
    s_add_u32 s50, s47, 82944
    buffer_load_dwordx4 v4, s[28:31], s50 offen  lds
    s_add_u32 m0, s48, 86016
    s_add_u32 s50, s47, 165888
    buffer_load_dwordx4 v4, s[28:31], s50 offen  lds
    s_add_u32 m0, s48, 90112
    s_add_u32 s50, s47, 248832
    buffer_load_dwordx4 v4, s[28:31], s50 offen  lds
    s_barrier
    s_add_u32 m0, s48, 94208
    s_add_u32 s50, s46, 1575936
    buffer_load_dwordx4 v4, s[28:31], s50 offen  lds
    s_add_u32 m0, s48, 98304
    s_add_u32 s50, s46, 1658880
    buffer_load_dwordx4 v4, s[28:31], s50 offen  lds
    s_add_u32 m0, s48, 102400
    s_add_u32 s50, s46, 1741824
    buffer_load_dwordx4 v4, s[28:31], s50 offen  lds
    s_add_u32 m0, s48, 106496
    s_add_u32 s50, s46, 1824768
    buffer_load_dwordx4 v4, s[28:31], s50 offen  lds
    s_add_u32 m0, s61, 352
    s_mov_b64 exec, 1
    global_load_lds_dword v252, s[12:13]
    s_mov_b64 exec, -1
    s_add_u32 m0, s48, 110592
    s_add_u32 s50, s46, 1907712
    buffer_load_dwordx4 v4, s[28:31], s50 offen  lds
    s_add_u32 m0, s48, 114688
    s_add_u32 s50, s46, 1990656
    buffer_load_dwordx4 v4, s[28:31], s50 offen  lds
    s_add_u32 m0, s48, 0
    s_add_u32 s50, s46, 2073600
    buffer_load_dwordx4 v4, s[28:31], s50 offen  lds
    s_add_u32 m0, s48, 4096
    s_add_u32 s50, s46, 2156544
    buffer_load_dwordx4 v4, s[28:31], s50 offen  lds
    s_add_u32 m0, s48, 8192
    s_add_u32 s50, s46, 2239488
    buffer_load_dwordx4 v4, s[28:31], s50 offen  lds
    s_add_u32 m0, s48, 12288
    s_add_u32 s50, s46, 2322432
    buffer_load_dwordx4 v4, s[28:31], s50 offen  lds
    s_add_u32 m0, s48, 16384
    s_add_u32 s50, s46, 2405376
    buffer_load_dwordx4 v4, s[28:31], s50 offen  lds
    s_add_u32 m0, s48, 20480
    s_add_u32 s50, s46, 2488320
    buffer_load_dwordx4 v4, s[28:31], s50 offen  lds
    s_add_u32 m0, s61, 384
    s_mov_b64 exec, 1
    global_load_lds_dword v252, s[12:13]
    s_mov_b64 exec, -1
    s_mov_b32 s32, s8
    s_mov_b32 s33, s9
    s_mov_b32 s34, 41472
    s_mov_b32 s35, 0x20000
    v_lshlrev_b32 v108, 4, v0
    s_lshl_b32 s52, s45, 10
    s_barrier
    s_add_u32 s53, s52, 0
    s_add_u32 m0, s53, 67072
    s_nop 0
    buffer_load_dwordx4 v108, s[32:35], s53 offen lds
    s_add_u32 s53, s52, 4096
    s_add_u32 m0, s53, 67072
    s_nop 0
    buffer_load_dwordx4 v108, s[32:35], s53 offen lds
    s_add_u32 s53, s52, 8192
    s_add_u32 m0, s53, 67072
    s_nop 0
    buffer_load_dwordx4 v108, s[32:35], s53 offen lds
    s_add_u32 s53, s52, 12288
    s_add_u32 m0, s53, 67072
    s_nop 0
    buffer_load_dwordx4 v108, s[32:35], s53 offen lds
    s_add_u32 s53, s52, 16384
    s_add_u32 m0, s53, 67072
    s_nop 0
    buffer_load_dwordx4 v108, s[32:35], s53 offen lds
    s_add_u32 s53, s52, 20480
    s_add_u32 m0, s53, 67072
    s_nop 0
    buffer_load_dwordx4 v108, s[32:35], s53 offen lds
    s_add_u32 s53, s52, 24576
    s_add_u32 m0, s53, 67072
    s_nop 0
    buffer_load_dwordx4 v108, s[32:35], s53 offen lds
    s_add_u32 s53, s52, 28672
    s_add_u32 m0, s53, 67072
    s_nop 0
    buffer_load_dwordx4 v108, s[32:35], s53 offen lds
    s_add_u32 s53, s52, 32768
    s_add_u32 m0, s53, 67072
    s_nop 0
    buffer_load_dwordx4 v108, s[32:35], s53 offen lds
    s_add_u32 s53, s52, 36864
    s_add_u32 m0, s53, 67072
    s_nop 0
    buffer_load_dwordx4 v108, s[32:35], s53 offen lds
    s_cmp_lg_u32 s45, 0
    s_cbranch_scc1 L_wo40
    s_mov_b32 m0, 108032
    s_mov_b32 s53, 40960
    buffer_load_dwordx4 v108, s[32:35], s53 offen lds
L_wo40:
    s_add_u32 m0, s61, 416
    s_mov_b64 exec, 1
    global_load_lds_dword v252, s[12:13]
    s_mov_b64 exec, -1
    s_mov_b32 s40, s14
    s_mov_b32 s41, s15
    s_mov_b32 s42, 4646656
    s_mov_b32 s43, 0x20000
    s_mov_b32 s36, s10
    s_mov_b32 s37, s11
    s_mov_b32 s38, 576000
    s_mov_b32 s39, 0x20000
    s_mul_i32 s3, s17, 7
    s_mul_i32 s96, s22, 3
    s_add_u32 s3, s3, s96
    s_mul_i32 s96, s3, 3641
    s_lshr_b32 s96, s96, 16
    s_mul_i32 s96, s96, 18
    s_sub_u32 s3, s3, s96
    v_and_b32 v64, 15, v0
    v_lshrrev_b32 v65, 4, v0
    v_and_b32 v66, 7, v64
    v_lshlrev_b32 v13, 4, v66
    v_lshl_add_u32 v13, v65, 7, v13
    v_add_u32 v13, 39744, v13
    v_lshrrev_b32 v66, 2, v64
    v_lshl_add_u32 v66, v65, 2, v66
    v_mul_u32_u24 v14, 288, v66
    v_and_b32 v66, 3, v64
    v_lshl_add_u32 v14, v66, 3, v14
    s_lshl_b32 s96, s16, 5
    s_add_u32 s97, s96, 67072
    v_add_u32 v14, s97, v14
    v_lshrrev_b32 v66, 1, v64
    v_and_b32 v66, 3, v66
    v_and_b32 v67, 1, v64
    s_and_b32 s97, s3, 3
    s_lshl_b32 s97, s97, 2
    s_add_u32 s97, s97, 4
    v_add_u32 v66, s97, v66
    s_cmp_ge_u32 s3, 16
    s_cselect_b32 s98, 8, 0
    s_cselect_b32 s99, 0, 2
    v_mad_u32_u24 v66, v67, s98, v66
    v_and_b32 v68, 7, v66
    v_bfe_u32 v69, v66, 3, 1
    v_mad_u32_u24 v68, v68, 18, v69
    v_mul_u32_u24 v67, s99, v67
    v_sub_u32 v68, v68, v67
    s_lshr_b32 s97, s3, 2
    s_lshl_b32 s97, s97, 2
    s_mul_i32 s98, s22, 144
    s_add_u32 s98, s98, 16
    s_sub_u32 s98, s98, s97
    v_add_u32 v68, s98, v68
    v_cmp_gt_u32 vcc, 1000, v68
    v_cmp_gt_u32 s[98:99], 8, v64
    s_mul_i32 s97, s21, 1000
    s_and_b64 vcc, vcc, s[98:99]
    v_add_u32 v68, s97, v68
    v_mul_u32_u24 v68, 288, v68
    v_lshl_add_u32 v68, v65, 3, v68
    v_add_u32 v68, s96, v68
    v_mov_b32 v69, 0x80000000
    v_cndmask_b32 v15, v69, v68, vcc
    v_and_b32 v113, 15, v0
    v_lshrrev_b32 v114, 4, v0
    v_and_b32 v115, 1, v113
    v_lshlrev_b32 v115, 4, v115
    v_mov_b32 v116, 0x3f80
    v_lshlrev_b32 v115, v115, v116
    v_lshrrev_b32 v116, 1, v113
    v_cmp_eq_u32 vcc, 0, v116
    s_nop 1
    v_cndmask_b32 v100, 0, v115, vcc
    v_cmp_eq_u32 vcc, 1, v116
    s_nop 1
    v_cndmask_b32 v101, 0, v115, vcc
    v_cmp_eq_u32 vcc, 2, v116
    s_nop 1
    v_cndmask_b32 v102, 0, v115, vcc
    v_cmp_eq_u32 vcc, 3, v116
    s_nop 1
    v_cndmask_b32 v103, 0, v115, vcc
    v_cmp_eq_u32 vcc, 4, v116
    s_nop 1
    v_cndmask_b32 v104, 0, v115, vcc
    v_cmp_eq_u32 vcc, 5, v116
    s_nop 1
    v_cndmask_b32 v105, 0, v115, vcc
    v_cmp_eq_u32 vcc, 6, v116
    s_nop 1
    v_cndmask_b32 v106, 0, v115, vcc
    v_cmp_eq_u32 vcc, 7, v116
    s_nop 1
    v_cndmask_b32 v107, 0, v115, vcc
    v_lshlrev_b32 v108, 4, v0
    v_lshrrev_b32 v115, 1, v114
    v_lshlrev_b32 v109, 3, v115
    v_and_b32 v115, 3, v113
    v_lshl_add_u32 v109, v115, 7, v109
    v_lshrrev_b32 v115, 2, v113
    v_lshl_add_u32 v109, v115, 5, v109
    v_and_b32 v115, 1, v114
    v_lshl_add_u32 v109, v115, 4, v109
    s_mul_i32 s4, s18, 18
    s_add_u32 s4, s4, s3
    s_mul_i32 s4, s4, 18432
    s_sub_u32 s5, s16, 4
    s_lshl_b32 s10, s5, 11
    s_add_u32 s10, s10, s4
    s_add_u32 s11, s10, 9216
    s_lshl_b32 s96, s5, 9
    s_add_u32 s96, s96, 39744
    v_add_u32 v109, s96, v109
    s_mov_b32 s6, 0x4038aa3b
    s_mov_b32 s7, 0xbfb8aa3b
    v_mov_b32 v110, 0x42700000
    s_lshr_b32 s9, s3, 2
    s_add_u32 s9, s9, 1
    s_mov_b32 s4, 0x10001
    s_cmp_eq_u32 s5, 4
    s_cselect_b32 s8, 0, -1
    s_cmp_lg_u32 s16, 7
    s_cbranch_scc1 Lz_dryend
    s_mov_b32 s4, 0
    s_mov_b64 exec, 0
    s_branch Lz_dry
Lz_dryend:
    s_mov_b64 exec, -1
    s_mov_b32 s4, 0x10001
    s_branch Lsp5_in
Lsp5:
    s_sleep 2
Lsp5_in:
    ds_read_b32 v112, v3 offset:416
    s_waitcnt lgkmcnt(0)
    v_cmp_ne_u32 vcc, 0, v112
    s_and_b32 s62, vcc_lo, 0xf0
    s_cbranch_scc1 Lsp5
    ds_read_b64_tr_b16 v[120:121], v14 offset:0
    ds_read_b64_tr_b16 v[122:123], v14 offset:4608
    ds_read_b64_tr_b16 v[124:125], v14 offset:9216
    ds_read_b64_tr_b16 v[126:127], v14 offset:13824
    ds_read_b64_tr_b16 v[128:129], v14 offset:18432
    ds_read_b64_tr_b16 v[130:131], v14 offset:23040
    ds_read_b64_tr_b16 v[132:133], v14 offset:27648
    ds_read_b64_tr_b16 v[134:135], v14 offset:32256
    ds_read_b64_tr_b16 v[136:137], v14 offset:36864
    s_branch Lz_start
L_fin:
L_end:
    s_endpgm
L_codeend:
.section .rodata,"a"
.p2align 6
.amdhsa_kernel standalone__autoregressive_conv_wavenet__speech_kernel
  .amdhsa_next_free_vgpr 256
  .amdhsa_next_free_sgpr 100
  .amdhsa_accum_offset 256
  .amdhsa_group_segment_fixed_size 0
  .amdhsa_kernarg_size 48
  .amdhsa_user_sgpr_count 2
  .amdhsa_user_sgpr_kernarg_segment_ptr 1
  .amdhsa_system_sgpr_workgroup_id_x 1
.end_amdhsa_kernel
```
